```python
import torch

def _softmax(x, axis=-1):
    return torch.softmax(x, dim=axis)
def _gelu(x):
    return torch.nn.functional.gelu(x, approximate="tanh")
def _silu(x):
    return torch.nn.functional.silu(x)
def _sigmoid(x):
    return torch.sigmoid(x)
def _layernorm(x, axis=-1, eps=1e-5):
    m = x.mean(dim=axis, keepdim=True)
    v = x.var(dim=axis, keepdim=True, unbiased=False)
    return (x - m) / torch.sqrt(v + eps)
def _scatter_add(tgt, idx, src, axis=0):
    return tgt.clone().index_add_(axis, idx, src)
def _segment_sum(src, seg, n):
    out = torch.zeros((n,) + src.shape[1:], dtype=src.dtype)
    return out.index_add_(0, seg, src)
def _pad(x, pw):
    flat = tuple(v for pair in reversed(pw) for v in pair)
    return torch.nn.functional.pad(x, flat)

kernel_name = 'standalone__gqa_softmax__near_ridge'

def setup_inputs():

    _w = (lambda a: (lambda t: t.to(torch.bfloat16) if t.is_floating_point() else t)(torch.as_tensor(a)))
    B, Hq, Hkv, Sq, Sk, D = 8, 32, 8, 128, 2048, 128
    return {
        "q": _w((lambda *s: torch.randn(*s, dtype=torch.bfloat16) * 0.8)(B, Hq, Sq, D)),
        "k": _w((lambda *s: torch.randn(*s, dtype=torch.bfloat16) * 0.8)(B, Hkv, Sk, D)),
        "v": _w((lambda *s: torch.randn(*s, dtype=torch.bfloat16) * 0.05)(B, Hkv, Sk, D)),
    }

def reference(q, k, v):
    B, Hq, Sq, D = q.shape
    Hkv = k.shape[1]
    rep = Hq // Hkv
    k = (lambda x, n, axis: torch.repeat_interleave(x, n, dim=axis))(k, rep, axis=1)
    v = (lambda x, n, axis: torch.repeat_interleave(x, n, dim=axis))(v, rep, axis=1)
    scale = D ** -0.5
    scores = torch.einsum("bhqd,bhkd->bhqk", q, k) * scale
    p = _softmax(scores, axis=-1)
    return torch.einsum("bhqk,bhkd->bhqd", p, v)
```

```asm
; @launch grid=(256,1,1) block=(256,1,1) lds=141376
.amdgcn_target "amdgcn-amd-amdhsa--gfx950"
.text
.globl standalone__gqa_softmax__near_ridge_kernel
.p2align 8
.type standalone__gqa_softmax__near_ridge_kernel,@function
standalone__gqa_softmax__near_ridge_kernel:
    s_load_dwordx4 s[4:7], s[0:1], 0
    s_load_dwordx4 s[8:11], s[0:1], 16
    s_lshr_b32 s32, s2, 3
    s_cmp_ge_u32 s32, 32
    s_cbranch_scc1 L_end
    v_lshrrev_b32 v1, 6, v0
    v_and_b32 v242, 63, v0
    v_readfirstlane_b32 s12, v1
    s_min_u32 s31, s32, 22
    s_lshl_b32 s31, s31, 10
    s_getpc_b64 s[52:53]
    v_lshl_add_u32 v2, v0, 2, s31
    global_load_dword v15, v2, s[52:53] offset:192
    s_bfe_u32 s33, s32, 0x20002
    s_and_b32 s31, s32, 3
    s_lshl2_add_u32 s33, s31, s33
    s_lshr_b32 s31, s32, 4
    s_lshl_b32 s31, s31, 4
    s_or_b32 s32, s33, s31
    s_and_b32 s31, s2, 7
    s_lshl_b32 s31, s31, 5
    s_or_b32 s33, s31, s32
    v_lshlrev_b32 v240, 4, v242
    v_add_u32 v241, 0x1000, v240
    v_lshl_add_u32 v244, v1, 13, v241
    s_lshl_b32 s36, s33, 15
    s_lshr_b32 s13, s12, 1
    s_and_b32 s14, s12, 1
    s_lshr_b32 s34, s33, 2
    s_lshl_b32 s34, s34, 1
    s_add_u32 s34, s34, s14
    s_lshl_b32 s34, s34, 5
    s_add_u32 s34, s34, s13
    s_lshl_b32 s34, s34, 13
    s_mul_i32 s37, s14, 67584
    s_mul_i32 s24, s13, 8448
    s_add_u32 s24, s24, s37
    s_mov_b32 s27, 0
    v_mov_b32 v252, 0
    v_mov_b32 v253, v252
    v_mov_b32 v254, v252
    v_mov_b32 v255, v252
    s_lshr_b32 s100, s33, 2
    s_lshl_b32 s100, s100, 19
    s_waitcnt lgkmcnt(0)
    s_add_u32 s48, s4, s36
    s_addc_u32 s49, s5, 0
L_restart:
    global_load_dwordx4 v[80:83], v244, s[48:49] offset:-4096 nt
    global_load_dwordx4 v[84:87], v244, s[48:49] offset:-3072 nt
    s_load_dwordx8 s[64:71], s[8:9], s100 offset:800
    s_load_dwordx8 s[72:79], s[8:9], s100 offset:264640
    global_load_dwordx4 v[88:91], v244, s[48:49] offset:-2048 nt
    global_load_dwordx4 v[92:95], v244, s[48:49] offset:-1024 nt
    global_load_dwordx4 v[96:99], v244, s[48:49] offset:0 nt
    global_load_dwordx4 v[100:103], v244, s[48:49] offset:1024 nt
    global_load_dwordx4 v[104:107], v244, s[48:49] offset:2048 nt
    global_load_dwordx4 v[108:111], v244, s[48:49] offset:3072 nt
    s_add_u32 s16, s6, s34
    s_addc_u32 s17, s7, 0
    s_add_u32 m0, s24, 4096
    v_mov_b32 v228, 0
    global_load_lds_dwordx4 v241, s[16:17] offset:-4096 nt
    s_add_u32 m0, s24, 4128
    v_mov_b32 v229, 0
    global_load_lds_dwordx4 v241, s[16:17] offset:-3072 nt
    s_add_u32 m0, s24, 4160
    v_mov_b32 v230, 0
    global_load_lds_dwordx4 v241, s[16:17] offset:-2048 nt
    s_add_u32 m0, s24, 4192
    v_mov_b32 v231, 0
    global_load_lds_dwordx4 v241, s[16:17] offset:-1024 nt
    s_mov_b64 s[20:21], s[16:17]
    s_add_u32 s22, s8, s34
    s_addc_u32 s23, s9, 0
    s_mov_b64 s[18:19], s[22:23]
    s_add_u32 s50, s10, s36
    s_addc_u32 s51, s11, 0
    s_add_u32 s2, s22, 0x3c000
    s_addc_u32 s3, s23, 0
    s_movk_i32 s26, 0x4000
    s_mov_b32 s25, -7
    s_mov_b32 s28, 0x3e0293ee
    s_mov_b32 s29, s28
    s_mov_b32 s46, 0xc2300000
    v_and_b32 v1, 15, v242
    v_mul_u32_u24 v1, 1056, v1
    v_lshrrev_b32 v2, 4, v242
    v_lshl_add_u32 v1, v2, 4, v1
    v_add_u32 v238, s37, v1
    s_mul_i32 s31, s13, 67584
    s_add_u32 s31, s31, 50688
    s_lshl_b32 s32, s14, 9
    s_add_u32 s35, s31, s32
    s_sub_u32 s38, s31, s32
    v_add_u32 v12, s35, v1
    v_add_u32 v13, s38, v1
    v_mul_u32_u24 v2, 1056, v2
    v_and_b32 v3, 0xf0, v240
    v_add3_u32 v14, v2, v3, s35
    v_lshrrev_b32 v1, 2, v242
    v_mul_u32_u24 v1, 1056, v1
    v_and_b32 v2, 3, v242
    v_lshl_add_u32 v1, v2, 3, v1
    v_add_u32 v239, s37, v1
    v_mov_b32 v224, 0x3f803f80
    v_bfe_u32 v3, v242, 1, 3
    v_cmp_eq_u32 vcc, 0, v3
    v_and_b32 v1, 1, v242
    v_sub_u32 v1, 0, v1
    v_cndmask_b32 v224, 0, v224, vcc
    v_and_b32 v1, 0xaaaaaaaa, v1
    v_or_b32 v243, 0x44444444, v1
    v_mov_b32 v225, v224
    v_mov_b32 v226, v224
    v_mov_b32 v227, v224
    s_mul_i32 s31, s13, 33792
    s_add_u32 s31, s31, 16896
    s_add_u32 s32, s31, s37
    s_xor_b32 s35, s14, 1
    s_mul_i32 s35, s35, 67584
    s_add_u32 s35, s35, s31
    s_mov_b32 s30, 0x51800000
    s_mov_b32 s47, 0x3a000000
    v_cmp_eq_u32 vcc, 1, v3
    v_mov_b32 v249, 0x3f803f80
    s_nop 0
    v_cndmask_b32 v249, 0, v249, vcc
    v_add_u32 v8, s32, v240
    v_add_u32 v9, s35, v240
    s_lshl_b32 s31, s12, 2
    s_add_u32 s31, s31, 135168
    v_mov_b32 v251, s31
    v_lshrrev_b32 v1, 4, v242
    v_and_b32 v2, 15, v242
    v_mul_u32_u24 v245, 576, v1
    v_lshl_add_u32 v245, v2, 3, v245
    v_add_u32 v245, s35, v245
    s_lshl_b32 s31, s12, 9
    s_add_u32 s31, s31, 139328
    v_lshl_add_u32 v246, v2, 2, s31
    v_lshl_add_u32 v248, v1, 4, s31
    s_xor_b32 s31, s12, 1
    s_lshl_b32 s31, s31, 9
    s_add_u32 s31, s31, 139328
    v_lshl_add_u32 v10, v2, 2, s31
    v_min_u32 v11, 1, v1
    v_mul_u32_u24 v11, 2560, v11
    v_sub_u32 v10, v10, v11
    v_sub_u32 v246, v246, v11
    v_mul_u32_u24 v250, 288, v1
    v_and_b32 v1, 3, v242
    v_lshl_add_u32 v250, v1, 6, v250
    v_bfe_u32 v2, v242, 2, 2
    v_lshl_add_u32 v250, v2, 3, v250
    v_add_u32 v250, s35, v250
    s_lshl_b32 s31, s12, 13
    s_add_u32 s31, s31, 0x1000
    v_lshl_add_u32 v247, v1, 5, s31
    v_bfe_u32 v2, v242, 2, 1
    v_lshl_add_u32 v247, v2, 4, v247
    v_lshrrev_b32 v1, 3, v242
    v_lshl_add_u32 v247, v1, 8, v247
    s_lshl_b32 s44, s27, 8
    s_mov_b32 s15, 0x2ac00000
    s_mov_b32 s39, 0xaac00000
    v_mov_b32 v232, 0
    v_mov_b32 v233, 0
    v_mov_b32 v234, 0
    v_mov_b32 v235, 0
    v_mov_b32 v236, 0
    v_mov_b32 v237, 0
    v_mov_b32 v16, s15
    v_mov_b32 v17, s15
    v_mov_b32 v18, s15
    v_mov_b32 v19, s15
    v_mov_b32 v20, s15
    v_mov_b32 v21, s15
    v_mov_b32 v22, s15
    v_mov_b32 v23, s15
    v_mov_b32 v24, s15
    v_mov_b32 v25, s15
    v_mov_b32 v26, s15
    v_mov_b32 v27, s15
    v_mov_b32 v28, s15
    v_mov_b32 v29, s15
    v_mov_b32 v30, s15
    v_mov_b32 v31, s15
    v_mov_b32 v32, s15
    v_mov_b32 v33, s15
    v_mov_b32 v34, s15
    v_mov_b32 v35, s15
    v_mov_b32 v36, s15
    v_mov_b32 v37, s15
    v_mov_b32 v38, s15
    v_mov_b32 v39, s15
    v_mov_b32 v40, s15
    v_mov_b32 v41, s15
    v_mov_b32 v42, s15
    v_mov_b32 v43, s15
    v_mov_b32 v44, s15
    v_mov_b32 v45, s15
    v_mov_b32 v46, s15
    v_mov_b32 v47, s15
    v_mov_b32 v48, s15
    v_mov_b32 v49, s15
    v_mov_b32 v50, s15
    v_mov_b32 v51, s15
    v_mov_b32 v52, s15
    v_mov_b32 v53, s15
    v_mov_b32 v54, s15
    v_mov_b32 v55, s15
    v_mov_b32 v56, s15
    v_mov_b32 v57, s15
    v_mov_b32 v58, s15
    v_mov_b32 v59, s15
    v_mov_b32 v60, s15
    v_mov_b32 v61, s15
    v_mov_b32 v62, s15
    v_mov_b32 v63, s15
    v_mov_b32 v64, s15
    v_mov_b32 v65, s15
    v_mov_b32 v66, s15
    v_mov_b32 v67, s15
    v_mov_b32 v68, s15
    v_mov_b32 v69, s15
    v_mov_b32 v70, s15
    v_mov_b32 v71, s15
    v_mov_b32 v72, s15
    v_mov_b32 v73, s15
    v_mov_b32 v74, s15
    v_mov_b32 v75, s15
    v_mov_b32 v76, s15
    v_mov_b32 v77, s15
    v_mov_b32 v78, s15
    v_mov_b32 v79, s15
    v_accvgpr_write_b32 a0, s39
    v_accvgpr_write_b32 a1, s39
    v_accvgpr_write_b32 a2, s39
    v_accvgpr_write_b32 a3, s39
    v_accvgpr_write_b32 a4, s39
    v_accvgpr_write_b32 a5, s39
    v_accvgpr_write_b32 a6, s39
    v_accvgpr_write_b32 a7, s39
    v_accvgpr_write_b32 a8, s39
    v_accvgpr_write_b32 a9, s39
    v_accvgpr_write_b32 a10, s39
    v_accvgpr_write_b32 a11, s39
    v_accvgpr_write_b32 a12, s39
    v_accvgpr_write_b32 a13, s39
    v_accvgpr_write_b32 a14, s39
    v_accvgpr_write_b32 a15, s39
    v_accvgpr_write_b32 a16, s39
    v_accvgpr_write_b32 a17, s39
    v_accvgpr_write_b32 a18, s39
    v_accvgpr_write_b32 a19, s39
    v_accvgpr_write_b32 a20, s39
    v_accvgpr_write_b32 a21, s39
    v_accvgpr_write_b32 a22, s39
    v_accvgpr_write_b32 a23, s39
    v_accvgpr_write_b32 a24, s39
    v_accvgpr_write_b32 a25, s39
    v_accvgpr_write_b32 a26, s39
    v_accvgpr_write_b32 a27, s39
    v_accvgpr_write_b32 a28, s39
    v_accvgpr_write_b32 a29, s39
    v_accvgpr_write_b32 a30, s39
    v_accvgpr_write_b32 a31, s39
    v_accvgpr_write_b32 a32, s39
    v_accvgpr_write_b32 a33, s39
    v_accvgpr_write_b32 a34, s39
    v_accvgpr_write_b32 a35, s39
    v_accvgpr_write_b32 a36, s39
    v_accvgpr_write_b32 a37, s39
    v_accvgpr_write_b32 a38, s39
    v_accvgpr_write_b32 a39, s39
    v_accvgpr_write_b32 a40, s39
    v_accvgpr_write_b32 a41, s39
    v_accvgpr_write_b32 a42, s39
    v_accvgpr_write_b32 a43, s39
    v_accvgpr_write_b32 a44, s39
    v_accvgpr_write_b32 a45, s39
    v_accvgpr_write_b32 a46, s39
    v_accvgpr_write_b32 a47, s39
    v_accvgpr_write_b32 a48, s39
    v_accvgpr_write_b32 a49, s39
    v_accvgpr_write_b32 a50, s39
    v_accvgpr_write_b32 a51, s39
    v_accvgpr_write_b32 a52, s39
    v_accvgpr_write_b32 a53, s39
    v_accvgpr_write_b32 a54, s39
    v_accvgpr_write_b32 a55, s39
    v_accvgpr_write_b32 a56, s39
    v_accvgpr_write_b32 a57, s39
    v_accvgpr_write_b32 a58, s39
    v_accvgpr_write_b32 a59, s39
    v_accvgpr_write_b32 a60, s39
    v_accvgpr_write_b32 a61, s39
    v_accvgpr_write_b32 a62, s39
    v_accvgpr_write_b32 a63, s39
    s_mov_b64 exec, 0
    s_cmp_eq_u32 s12, 0
    s_cbranch_scc1 L_pad0
    s_cmp_eq_u32 s12, 1
    s_cbranch_scc1 L_pad1
    s_cmp_eq_u32 s12, 2
    s_cbranch_scc1 L_pad2
    s_branch L_pad3
.p2align 12
.fill 821, 4, 0xbf800000
L_pad3:
L_x:
    s_mov_b64 exec, -1
    s_add_u32 m0, s24, 4224
    s_nop 0
    global_load_lds_dwordx4 v241, s[16:17] offset:0 nt
    s_add_u32 m0, s24, 4256
    s_nop 0
    global_load_lds_dwordx4 v241, s[16:17] offset:1024 nt
    s_add_u32 m0, s24, 4288
    s_nop 0
    global_load_lds_dwordx4 v241, s[16:17] offset:2048 nt
    s_add_u32 m0, s24, 4320
    s_nop 0
    global_load_lds_dwordx4 v241, s[16:17] offset:3072 nt
    s_add_u32 s16, s16, s26
    s_addc_u32 s17, s17, 0
    s_waitcnt vmcnt(15)
    v_lshlrev_b32 v0, 16, v80
    v_and_b32 v1, 0xffff0000, v80
    v_lshlrev_b32 v2, 16, v81
    v_and_b32 v3, 0xffff0000, v81
    v_lshlrev_b32 v4, 16, v82
    v_and_b32 v5, 0xffff0000, v82
    v_lshlrev_b32 v6, 16, v83
    v_and_b32 v7, 0xffff0000, v83
    v_pk_mul_f32 v[0:1], v[0:1], s[28:29]
    v_pk_mul_f32 v[2:3], v[2:3], s[28:29]
    v_pk_mul_f32 v[4:5], v[4:5], s[28:29]
    v_pk_mul_f32 v[6:7], v[6:7], s[28:29]
    v_cvt_pk_bf16_f32 v80, v0, v1
    v_cvt_pk_bf16_f32 v81, v2, v3
    v_cvt_pk_bf16_f32 v82, v4, v5
    v_cvt_pk_bf16_f32 v83, v6, v7
    ds_write_b128 v14, v[80:83] offset:0
    s_waitcnt lgkmcnt(0)
    s_max_u32 s64, s64, s65
    s_max_u32 s72, s72, s73
    s_max_u32 s64, s64, s66
    s_max_u32 s72, s72, s74
    s_max_u32 s64, s64, s67
    s_max_u32 s72, s72, s75
    s_max_u32 s64, s64, s68
    s_max_u32 s72, s72, s76
    s_max_u32 s64, s64, s69
    s_max_u32 s72, s72, s77
    s_max_u32 s64, s64, s70
    s_max_u32 s72, s72, s78
    s_max_u32 s64, s64, s71
    s_max_u32 s72, s72, s79
    s_bfe_u32 s64, s64, 0x80017
    s_bfe_u32 s72, s72, 0x80017
    s_min_i32 s45, s64, s72
    s_sub_i32 s45, s45, 110
    s_min_i32 s45, s45, 31
    s_cmp_le_i32 s45, s44
    s_cbranch_scc1 L_nooff
L_off:
    s_lshl_b32 s46, s45, 18
    s_or_b32 s46, s46, 0xc2000000
    s_lshl_b32 s30, s45, 23
    v_sub_f32 v208, s46, v252
    v_sub_f32 v209, s46, v252
    v_sub_f32 v210, s46, v252
    v_sub_f32 v211, s46, v252
    v_sub_f32 v212, s46, v253
    v_sub_f32 v213, s46, v253
    v_sub_f32 v214, s46, v253
    v_sub_f32 v215, s46, v253
    v_sub_f32 v216, s46, v254
    v_sub_f32 v217, s46, v254
    v_sub_f32 v218, s46, v254
    v_sub_f32 v219, s46, v254
    v_sub_f32 v220, s46, v255
    v_sub_f32 v221, s46, v255
    v_sub_f32 v222, s46, v255
    v_sub_f32 v223, s46, v255
    s_add_u32 s30, s30, 0x4d800000
    s_waitcnt vmcnt(14)
    v_lshlrev_b32 v0, 16, v84
    v_and_b32 v1, 0xffff0000, v84
    v_lshlrev_b32 v2, 16, v85
    v_and_b32 v3, 0xffff0000, v85
    v_lshlrev_b32 v4, 16, v86
    v_and_b32 v5, 0xffff0000, v86
    v_lshlrev_b32 v6, 16, v87
    v_and_b32 v7, 0xffff0000, v87
    v_pk_mul_f32 v[0:1], v[0:1], s[28:29]
    v_pk_mul_f32 v[2:3], v[2:3], s[28:29]
    v_pk_mul_f32 v[4:5], v[4:5], s[28:29]
    v_pk_mul_f32 v[6:7], v[6:7], s[28:29]
    v_cvt_pk_bf16_f32 v84, v0, v1
    v_cvt_pk_bf16_f32 v85, v2, v3
    v_cvt_pk_bf16_f32 v86, v4, v5
    v_cvt_pk_bf16_f32 v87, v6, v7
    ds_write_b128 v14, v[84:87] offset:4224
    s_waitcnt vmcnt(13)
    v_lshlrev_b32 v0, 16, v88
    v_and_b32 v1, 0xffff0000, v88
    v_lshlrev_b32 v2, 16, v89
    v_and_b32 v3, 0xffff0000, v89
    v_lshlrev_b32 v4, 16, v90
    v_and_b32 v5, 0xffff0000, v90
    v_lshlrev_b32 v6, 16, v91
    v_and_b32 v7, 0xffff0000, v91
    v_pk_mul_f32 v[0:1], v[0:1], s[28:29]
    v_pk_mul_f32 v[2:3], v[2:3], s[28:29]
    v_pk_mul_f32 v[4:5], v[4:5], s[28:29]
    v_pk_mul_f32 v[6:7], v[6:7], s[28:29]
    v_cvt_pk_bf16_f32 v88, v0, v1
    v_cvt_pk_bf16_f32 v89, v2, v3
    v_cvt_pk_bf16_f32 v90, v4, v5
    v_cvt_pk_bf16_f32 v91, v6, v7
    ds_write_b128 v14, v[88:91] offset:8448
    s_waitcnt vmcnt(12)
    v_lshlrev_b32 v0, 16, v92
    v_and_b32 v1, 0xffff0000, v92
    v_lshlrev_b32 v2, 16, v93
    v_and_b32 v3, 0xffff0000, v93
    v_lshlrev_b32 v4, 16, v94
    v_and_b32 v5, 0xffff0000, v94
    v_lshlrev_b32 v6, 16, v95
    v_and_b32 v7, 0xffff0000, v95
    v_pk_mul_f32 v[0:1], v[0:1], s[28:29]
    v_pk_mul_f32 v[2:3], v[2:3], s[28:29]
    v_pk_mul_f32 v[4:5], v[4:5], s[28:29]
    v_pk_mul_f32 v[6:7], v[6:7], s[28:29]
    v_cvt_pk_bf16_f32 v92, v0, v1
    v_cvt_pk_bf16_f32 v93, v2, v3
    v_cvt_pk_bf16_f32 v94, v4, v5
    v_cvt_pk_bf16_f32 v95, v6, v7
    ds_write_b128 v14, v[92:95] offset:12672
    s_waitcnt vmcnt(11)
    v_lshlrev_b32 v0, 16, v96
    v_and_b32 v1, 0xffff0000, v96
    v_lshlrev_b32 v2, 16, v97
    v_and_b32 v3, 0xffff0000, v97
    v_lshlrev_b32 v4, 16, v98
    v_and_b32 v5, 0xffff0000, v98
    v_lshlrev_b32 v6, 16, v99
    v_and_b32 v7, 0xffff0000, v99
    v_pk_mul_f32 v[0:1], v[0:1], s[28:29]
    v_pk_mul_f32 v[2:3], v[2:3], s[28:29]
L_pad0:
    s_cbranch_execz L_x
    v_pk_mul_f32 v[4:5], v[4:5], s[28:29]
    v_pk_mul_f32 v[6:7], v[6:7], s[28:29]
    v_cvt_pk_bf16_f32 v96, v0, v1
    v_cvt_pk_bf16_f32 v97, v2, v3
    v_cvt_pk_bf16_f32 v98, v4, v5
    v_cvt_pk_bf16_f32 v99, v6, v7
    ds_write_b128 v14, v[96:99] offset:256
    s_add_u32 m0, s24, 20992
    s_nop 0
    global_load_lds_dwordx4 v241, s[16:17] offset:-4096 nt
    s_add_u32 m0, s24, 21024
    s_nop 0
    global_load_lds_dwordx4 v241, s[16:17] offset:-3072 nt
    s_add_u32 m0, s24, 21056
    s_nop 0
    global_load_lds_dwordx4 v241, s[16:17] offset:-2048 nt
    s_waitcnt vmcnt(13)
    v_lshlrev_b32 v0, 16, v100
    v_and_b32 v1, 0xffff0000, v100
    v_lshlrev_b32 v2, 16, v101
    v_and_b32 v3, 0xffff0000, v101
    v_lshlrev_b32 v4, 16, v102
    v_and_b32 v5, 0xffff0000, v102
    v_lshlrev_b32 v6, 16, v103
    v_and_b32 v7, 0xffff0000, v103
    v_pk_mul_f32 v[0:1], v[0:1], s[28:29]
    v_pk_mul_f32 v[2:3], v[2:3], s[28:29]
    v_pk_mul_f32 v[4:5], v[4:5], s[28:29]
    v_pk_mul_f32 v[6:7], v[6:7], s[28:29]
    v_cvt_pk_bf16_f32 v100, v0, v1
    v_cvt_pk_bf16_f32 v101, v2, v3
    v_cvt_pk_bf16_f32 v102, v4, v5
    v_cvt_pk_bf16_f32 v103, v6, v7
    ds_write_b128 v14, v[100:103] offset:4480
    s_add_u32 m0, s24, 21088
    s_nop 0
    global_load_lds_dwordx4 v241, s[16:17] offset:-1024 nt
    s_add_u32 m0, s24, 21120
    s_nop 0
    global_load_lds_dwordx4 v241, s[16:17] offset:0 nt
    s_add_u32 m0, s24, 21152
    s_nop 0
    global_load_lds_dwordx4 v241, s[16:17] offset:1024 nt
    s_waitcnt vmcnt(15)
    v_lshlrev_b32 v0, 16, v104
    v_and_b32 v1, 0xffff0000, v104
    v_lshlrev_b32 v2, 16, v105
    v_and_b32 v3, 0xffff0000, v105
    v_lshlrev_b32 v4, 16, v106
    v_and_b32 v5, 0xffff0000, v106
    v_lshlrev_b32 v6, 16, v107
    v_and_b32 v7, 0xffff0000, v107
    v_pk_mul_f32 v[0:1], v[0:1], s[28:29]
    v_pk_mul_f32 v[2:3], v[2:3], s[28:29]
    v_pk_mul_f32 v[4:5], v[4:5], s[28:29]
    v_pk_mul_f32 v[6:7], v[6:7], s[28:29]
    v_cvt_pk_bf16_f32 v104, v0, v1
    v_cvt_pk_bf16_f32 v105, v2, v3
    v_cvt_pk_bf16_f32 v106, v4, v5
    v_cvt_pk_bf16_f32 v107, v6, v7
    ds_write_b128 v14, v[104:107] offset:8704
    s_add_u32 m0, s24, 21184
    s_nop 0
    global_load_lds_dwordx4 v241, s[16:17] offset:2048 nt
    s_add_u32 m0, s24, 21216
    s_nop 0
    global_load_lds_dwordx4 v241, s[16:17] offset:3072 nt
    s_add_u32 s16, s16, s26
    s_addc_u32 s17, s17, 0
    s_waitcnt vmcnt(16)
    v_lshlrev_b32 v0, 16, v108
    v_and_b32 v1, 0xffff0000, v108
    v_lshlrev_b32 v2, 16, v109
    v_and_b32 v3, 0xffff0000, v109
    v_lshlrev_b32 v4, 16, v110
    v_and_b32 v5, 0xffff0000, v110
    v_lshlrev_b32 v6, 16, v111
    v_and_b32 v7, 0xffff0000, v111
    v_pk_mul_f32 v[0:1], v[0:1], s[28:29]
    v_pk_mul_f32 v[2:3], v[2:3], s[28:29]
    v_pk_mul_f32 v[4:5], v[4:5], s[28:29]
    v_pk_mul_f32 v[6:7], v[6:7], s[28:29]
    v_cvt_pk_bf16_f32 v108, v0, v1
    v_cvt_pk_bf16_f32 v109, v2, v3
    v_cvt_pk_bf16_f32 v110, v4, v5
    v_cvt_pk_bf16_f32 v111, v6, v7
    ds_write_b128 v14, v[108:111] offset:12928
    ds_read_b128 a[64:67], v12 offset:0
    ds_read_b128 a[68:71], v12 offset:64
    ds_read_b128 a[72:75], v12 offset:128
    ds_read_b128 a[76:79], v12 offset:192
    ds_read_b128 a[80:83], v12 offset:256
    ds_read_b128 a[84:87], v12 offset:320
    ds_read_b128 a[88:91], v12 offset:384
    ds_read_b128 a[92:95], v12 offset:448
    s_waitcnt lgkmcnt(8)
    s_barrier
    ds_read_b128 a[96:99], v13 offset:512
    ds_read_b128 a[100:103], v13 offset:576
    ds_read_b128 a[104:107], v13 offset:640
    ds_read_b128 a[108:111], v13 offset:704
    ds_read_b128 a[112:115], v13 offset:768
    ds_read_b128 a[116:119], v13 offset:832
    ds_read_b128 a[120:123], v13 offset:896
    ds_read_b128 a[124:127], v13 offset:960
    s_waitcnt vmcnt(8)
    s_barrier
    ds_read_b128 a[192:195], v238 offset:0
    ds_read_b128 a[196:199], v238 offset:64
    ds_read_b128 a[200:203], v238 offset:128
    ds_read_b128 a[204:207], v238 offset:192
    s_add_u32 m0, s24, 37888
    v_mov_b32 v252, v249
    global_load_lds_dwordx4 v241, s[18:19] offset:-4096 nt
    ds_read_b128 a[208:211], v238 offset:256
    ds_read_b128 a[212:215], v238 offset:320
    ds_read_b128 a[216:219], v238 offset:384
    ds_read_b128 a[220:223], v238 offset:448
    s_add_u32 m0, s24, 37920
    v_mov_b32 v253, v249
    v_mov_b32 v254, v249
    v_mov_b32 v255, v249
    v_subrev_u32 v0, 32, v241
    v_subrev_u32 v1, 64, v241
    v_subrev_u32 v2, 96, v241
    v_subrev_u32 v3, 128, v241
    v_subrev_u32 v4, 160, v241
    v_subrev_u32 v5, 192, v241
    v_subrev_u32 v6, 224, v241
    global_load_lds_dwordx4 v241, s[18:19] offset:-3072 nt
    ds_read_b128 a[224:227], v238 offset:512
    ds_read_b128 a[228:231], v238 offset:576
    ds_read_b128 a[232:235], v238 offset:640
    s_waitcnt lgkmcnt(10)
    v_mfma_f32_16x16x32_bf16 v[80:83], a[192:195], a[64:67], v[208:211]
    s_waitcnt lgkmcnt(9)
    ds_read_b128 a[236:239], v238 offset:704
    s_add_u32 m0, s24, 37952
    v_mfma_f32_16x16x32_bf16 v[80:83], a[196:199], a[68:71], v[80:83]
    s_waitcnt lgkmcnt(9)
    v_mfma_f32_16x16x32_bf16 v[80:83], a[200:203], a[72:75], v[80:83]
    s_waitcnt lgkmcnt(8)
    v_mfma_f32_16x16x32_bf16 v[80:83], a[204:207], a[76:79], v[80:83]
    global_load_lds_dwordx4 v241, s[18:19] offset:-2048 nt
    v_mfma_f32_16x16x32_bf16 v[84:87], a[204:207], a[92:95], v[212:215]
    ds_read_b128 a[240:243], v238 offset:768
    v_mfma_f32_16x16x32_bf16 v[84:87], a[200:203], a[88:91], v[84:87]
    ds_read_b128 a[244:247], v238 offset:832
    v_mfma_f32_16x16x32_bf16 v[84:87], a[196:199], a[84:87], v[84:87]
    ds_read_b128 a[248:251], v238 offset:896
    v_mfma_f32_16x16x32_bf16 v[84:87], a[192:195], a[80:83], v[84:87]
    ds_read_b128 a[252:255], v238 offset:960
    v_exp_f32 v80, v80
    v_mfma_f32_16x16x32_bf16 v[88:91], a[192:195], a[96:99], v[216:219]
    s_add_u32 m0, s24, 37984
    v_exp_f32 v81, v81
    v_mfma_f32_16x16x32_bf16 v[88:91], a[196:199], a[100:103], v[88:91]
    global_load_lds_dwordx4 v241, s[18:19] offset:-1024 nt
    v_exp_f32 v82, v82
    v_mfma_f32_16x16x32_bf16 v[88:91], a[200:203], a[104:107], v[88:91]
    v_cvt_pk_bf16_f32 v144, v80, v81
    v_exp_f32 v83, v83
    v_mfma_f32_16x16x32_bf16 v[88:91], a[204:207], a[108:111], v[88:91]
    v_cvt_pk_bf16_f32 v145, v82, v83
    v_exp_f32 v84, v84
    v_mfma_f32_16x16x32_bf16 v[92:95], a[204:207], a[124:127], v[220:223]
    s_waitcnt lgkmcnt(0)
    s_barrier
    v_mfma_f32_16x16x32_bf16 v[92:95], a[200:203], a[120:123], v[92:95]
    s_add_u32 m0, s24, 38016
    v_exp_f32 v85, v85
    v_mfma_f32_16x16x32_bf16 v[92:95], a[196:199], a[116:119], v[92:95]
    global_load_lds_dwordx4 v241, s[18:19] offset:0 nt
    v_exp_f32 v86, v86
    v_mfma_f32_16x16x32_bf16 v[92:95], a[192:195], a[112:115], v[92:95]
    s_add_u32 m0, s24, 38048
    v_cvt_pk_bf16_f32 v152, v84, v85
    v_exp_f32 v87, v87
    v_mfma_f32_16x16x32_bf16 v[96:99], a[208:211], a[64:67], v[208:211]
    v_cvt_pk_bf16_f32 v153, v86, v87
    v_exp_f32 v88, v88
    v_mfma_f32_16x16x32_bf16 v[96:99], a[212:215], a[68:71], v[96:99]
    v_exp_f32 v89, v89
    v_mfma_f32_16x16x32_bf16 v[96:99], a[216:219], a[72:75], v[96:99]
    global_load_lds_dwordx4 v241, s[18:19] offset:1024 nt
    v_exp_f32 v90, v90
    v_mfma_f32_16x16x32_bf16 v[96:99], a[220:223], a[76:79], v[96:99]
    s_add_u32 m0, s24, 38080
    v_cvt_pk_bf16_f32 v160, v88, v89
    v_exp_f32 v91, v91
    v_mfma_f32_16x16x32_bf16 v[100:103], a[220:223], a[92:95], v[212:215]
    v_cvt_pk_bf16_f32 v161, v90, v91
    v_exp_f32 v92, v92
    v_mfma_f32_16x16x32_bf16 v[100:103], a[216:219], a[88:91], v[100:103]
    v_exp_f32 v93, v93
    v_mfma_f32_16x16x32_bf16 v[100:103], a[212:215], a[84:87], v[100:103]
    global_load_lds_dwordx4 v241, s[18:19] offset:2048 nt
    v_exp_f32 v94, v94
    v_mfma_f32_16x16x32_bf16 v[100:103], a[208:211], a[80:83], v[100:103]
    s_add_u32 m0, s24, 38112
    v_cvt_pk_bf16_f32 v168, v92, v93
    v_exp_f32 v95, v95
    v_mfma_f32_16x16x32_bf16 v[104:107], a[208:211], a[96:99], v[216:219]
    v_cvt_pk_bf16_f32 v169, v94, v95
    v_exp_f32 v96, v96
    v_mfma_f32_16x16x32_bf16 v[104:107], a[212:215], a[100:103], v[104:107]
    v_exp_f32 v97, v97
    v_mfma_f32_16x16x32_bf16 v[104:107], a[216:219], a[104:107], v[104:107]
    global_load_lds_dwordx4 v241, s[18:19] offset:3072 nt
    v_exp_f32 v98, v98
    v_mfma_f32_16x16x32_bf16 v[104:107], a[220:223], a[108:111], v[104:107]
    s_add_u32 s18, s18, s26
    s_addc_u32 s19, s19, 0
    v_exp_f32 v99, v99
    v_mfma_f32_16x16x32_bf16 v[108:111], a[220:223], a[124:127], v[220:223]
    s_add_u32 m0, s24, 4096
    v_cvt_pk_bf16_f32 v146, v96, v97
    v_exp_f32 v100, v100
    v_mfma_f32_16x16x32_bf16 v[108:111], a[216:219], a[120:123], v[108:111]
    v_cvt_pk_bf16_f32 v147, v98, v99
    v_exp_f32 v101, v101
    v_mfma_f32_16x16x32_bf16 v[108:111], a[212:215], a[116:119], v[108:111]
    global_load_lds_dwordx4 v241, s[16:17] offset:-4096 nt
    v_exp_f32 v102, v102
    v_mfma_f32_16x16x32_bf16 v[108:111], a[208:211], a[112:115], v[108:111]
    s_add_u32 m0, s24, 4128
    v_cvt_pk_bf16_f32 v154, v100, v101
    v_exp_f32 v103, v103
    v_mfma_f32_16x16x32_bf16 v[112:115], a[224:227], a[64:67], v[208:211]
    v_cvt_pk_bf16_f32 v155, v102, v103
    v_exp_f32 v104, v104
    v_mfma_f32_16x16x32_bf16 v[112:115], a[228:231], a[68:71], v[112:115]
    v_exp_f32 v105, v105
    v_mfma_f32_16x16x32_bf16 v[112:115], a[232:235], a[72:75], v[112:115]
    global_load_lds_dwordx4 v241, s[16:17] offset:-3072 nt
    v_exp_f32 v106, v106
    v_mfma_f32_16x16x32_bf16 v[112:115], a[236:239], a[76:79], v[112:115]
    s_add_u32 m0, s24, 4160
    v_cvt_pk_bf16_f32 v162, v104, v105
    v_exp_f32 v107, v107
    v_mfma_f32_16x16x32_bf16 v[116:119], a[236:239], a[92:95], v[212:215]
    v_cvt_pk_bf16_f32 v163, v106, v107
    v_exp_f32 v108, v108
    v_mfma_f32_16x16x32_bf16 v[116:119], a[232:235], a[88:91], v[116:119]
    v_exp_f32 v109, v109
    v_mfma_f32_16x16x32_bf16 v[116:119], a[228:231], a[84:87], v[116:119]
    global_load_lds_dwordx4 v241, s[16:17] offset:-2048 nt
    v_exp_f32 v110, v110
    v_mfma_f32_16x16x32_bf16 v[116:119], a[224:227], a[80:83], v[116:119]
    s_add_u32 m0, s24, 4192
    v_cvt_pk_bf16_f32 v170, v108, v109
    v_exp_f32 v111, v111
    v_mfma_f32_16x16x32_bf16 v[120:123], a[224:227], a[96:99], v[216:219]
    v_cvt_pk_bf16_f32 v171, v110, v111
    v_exp_f32 v112, v112
    v_mfma_f32_16x16x32_bf16 v[120:123], a[228:231], a[100:103], v[120:123]
    v_exp_f32 v113, v113
    v_mfma_f32_16x16x32_bf16 v[120:123], a[232:235], a[104:107], v[120:123]
    global_load_lds_dwordx4 v241, s[16:17] offset:-1024 nt
    v_exp_f32 v114, v114
    v_mfma_f32_16x16x32_bf16 v[120:123], a[236:239], a[108:111], v[120:123]
    s_waitcnt vmcnt(12)
    s_barrier
    v_mfma_f32_16x16x32_bf16 v[124:127], a[236:239], a[124:127], v[220:223]
    ds_read_b128 a[128:131], v238 offset:16896
    v_exp_f32 v115, v115
    v_mfma_f32_16x16x32_bf16 v[124:127], a[232:235], a[120:123], v[124:127]
    ds_read_b128 a[132:135], v238 offset:16960
    v_cvt_pk_bf16_f32 v148, v112, v113
    v_cvt_pk_bf16_f32 v149, v114, v115
    v_mfma_f32_16x16x32_bf16 v[124:127], a[228:231], a[116:119], v[124:127]
    ds_read_b128 a[136:139], v238 offset:17024
    v_exp_f32 v116, v116
    v_mfma_f32_16x16x32_bf16 v[124:127], a[224:227], a[112:115], v[124:127]
    s_add_u32 m0, s24, 4224
    v_exp_f32 v117, v117
    v_mfma_f32_16x16x32_bf16 v[128:131], a[240:243], a[64:67], v[208:211]
    global_load_lds_dwordx4 v241, s[16:17] offset:0 nt
    v_exp_f32 v118, v118
    v_mfma_f32_16x16x32_bf16 v[128:131], a[244:247], a[68:71], v[128:131]
    ds_read_b128 a[140:143], v238 offset:17088
    v_exp_f32 v119, v119
    v_mfma_f32_16x16x32_bf16 v[128:131], a[248:251], a[72:75], v[128:131]
    ds_read_b128 a[144:147], v238 offset:17152
    v_cvt_pk_bf16_f32 v156, v116, v117
    v_cvt_pk_bf16_f32 v157, v118, v119
    v_mfma_f32_16x16x32_bf16 v[128:131], a[252:255], a[76:79], v[128:131]
    ds_read_b128 a[148:151], v238 offset:17216
    v_exp_f32 v120, v120
    v_mfma_f32_16x16x32_bf16 v[132:135], a[252:255], a[92:95], v[212:215]
    s_add_u32 m0, s24, 4256
    v_exp_f32 v121, v121
    v_mfma_f32_16x16x32_bf16 v[132:135], a[248:251], a[88:91], v[132:135]
    global_load_lds_dwordx4 v241, s[16:17] offset:1024 nt
    v_exp_f32 v122, v122
    v_mfma_f32_16x16x32_bf16 v[132:135], a[244:247], a[84:87], v[132:135]
    s_add_u32 m0, s24, 4288
    v_cvt_pk_bf16_f32 v164, v120, v121
    v_exp_f32 v123, v123
    v_mfma_f32_16x16x32_bf16 v[132:135], a[240:243], a[80:83], v[132:135]
    v_cvt_pk_bf16_f32 v165, v122, v123
    v_exp_f32 v124, v124
    v_mfma_f32_16x16x32_bf16 v[136:139], a[240:243], a[96:99], v[216:219]
    v_exp_f32 v125, v125
    v_mfma_f32_16x16x32_bf16 v[136:139], a[244:247], a[100:103], v[136:139]
    global_load_lds_dwordx4 v241, s[16:17] offset:2048 nt
    v_exp_f32 v126, v126
    v_mfma_f32_16x16x32_bf16 v[136:139], a[248:251], a[104:107], v[136:139]
    s_add_u32 m0, s24, 4320
    v_cvt_pk_bf16_f32 v172, v124, v125
    v_exp_f32 v127, v127
    v_mfma_f32_16x16x32_bf16 v[136:139], a[252:255], a[108:111], v[136:139]
    v_cvt_pk_bf16_f32 v173, v126, v127
    v_exp_f32 v128, v128
    v_mfma_f32_16x16x32_bf16 v[140:143], a[252:255], a[124:127], v[220:223]
    v_exp_f32 v129, v129
    v_mfma_f32_16x16x32_bf16 v[140:143], a[248:251], a[120:123], v[140:143]
    global_load_lds_dwordx4 v241, s[16:17] offset:3072 nt
    v_exp_f32 v130, v130
    v_mfma_f32_16x16x32_bf16 v[140:143], a[244:247], a[116:119], v[140:143]
    s_add_u32 s16, s16, s26
    s_addc_u32 s17, s17, 0
    v_exp_f32 v131, v131
    v_mfma_f32_16x16x32_bf16 v[140:143], a[240:243], a[112:115], v[140:143]
    v_cvt_pk_bf16_f32 v150, v128, v129
    v_cvt_pk_bf16_f32 v151, v130, v131
    v_exp_f32 v132, v132
    v_exp_f32 v133, v133
    v_exp_f32 v134, v134
    v_exp_f32 v135, v135
    v_exp_f32 v136, v136
    v_exp_f32 v137, v137
    s_waitcnt lgkmcnt(2)
L_loop:
    v_mfma_f32_16x16x32_bf16 v[80:83], a[128:131], a[64:67], v[208:211]
    v_exp_f32 v138, v138
    v_mfma_f32_16x16x32_bf16 v[80:83], a[132:135], a[68:71], v[80:83]
    s_add_u32 m0, s24, 54784
    v_exp_f32 v139, v139
    v_mfma_f32_16x16x32_bf16 v[80:83], a[136:139], a[72:75], v[80:83]
    global_load_lds_dwordx4 v241, s[18:19] offset:-4096 nt
    v_mfma_f32_16x16x32_bf16 v[80:83], a[140:143], a[76:79], v[80:83]
    ds_read_b128 a[152:155], v238 offset:17280
    v_mfma_f32_16x16x32_bf16 v[84:87], a[140:143], a[92:95], v[212:215]
    v_exp_f32 v140, v140
    v_mfma_f32_16x16x32_bf16 v[84:87], a[136:139], a[88:91], v[84:87]
    ds_read_b128 a[156:159], v238 offset:17344
    v_cvt_pk_bf16_f32 v158, v132, v133
    v_mfma_f32_16x16x32_bf16 v[84:87], a[132:135], a[84:87], v[84:87]
    v_exp_f32 v141, v141
    v_mfma_f32_16x16x32_bf16 v[84:87], a[128:131], a[80:83], v[84:87]
    v_exp_f32 v142, v142
    v_mfma_f32_16x16x32_bf16 v[88:91], a[128:131], a[96:99], v[216:219]
    v_exp_f32 v143, v143
    v_mfma_f32_16x16x32_bf16 v[88:91], a[132:135], a[100:103], v[88:91]
    global_load_lds_dwordx4 v0, s[18:19] offset:-3040 nt
    v_mfma_f32_16x16x32_bf16 v[88:91], a[136:139], a[104:107], v[88:91]
    ds_read_b128 a[160:163], v238 offset:17408
    v_mfma_f32_16x16x32_bf16 v[88:91], a[140:143], a[108:111], v[88:91]
    v_exp_f32 v80, v80
    v_mfma_f32_16x16x32_bf16 v[92:95], a[140:143], a[124:127], v[220:223]
    v_exp_f32 v81, v81
    v_mfma_f32_16x16x32_bf16 v[92:95], a[136:139], a[120:123], v[92:95]
    ds_read_b128 a[164:167], v238 offset:17472
    v_cvt_pk_bf16_f32 v159, v134, v135
    v_mfma_f32_16x16x32_bf16 v[92:95], a[132:135], a[116:119], v[92:95]
    v_exp_f32 v82, v82
    v_mfma_f32_16x16x32_bf16 v[92:95], a[128:131], a[112:115], v[92:95]
    s_waitcnt lgkmcnt(2)
    v_exp_f32 v83, v83
    v_mfma_f32_16x16x32_bf16 v[108:111], a[144:147], a[112:115], v[220:223]
    global_load_lds_dwordx4 v1, s[18:19] offset:-1984 nt
    v_mfma_f32_16x16x32_bf16 v[108:111], a[148:151], a[116:119], v[108:111]
    v_exp_f32 v84, v84
    v_mfma_f32_16x16x32_bf16 v[108:111], a[152:155], a[120:123], v[108:111]
    ds_read_b128 a[168:171], v238 offset:17536
    v_cvt_pk_bf16_f32 v166, v136, v137
    v_mfma_f32_16x16x32_bf16 v[108:111], a[156:159], a[124:127], v[108:111]
    v_exp_f32 v85, v85
    v_mfma_f32_16x16x32_bf16 v[104:107], a[156:159], a[108:111], v[216:219]
    ds_read_b128 a[172:175], v238 offset:17600
    v_cvt_pk_bf16_f32 v167, v138, v139
    v_mfma_f32_16x16x32_bf16 v[104:107], a[152:155], a[104:107], v[104:107]
    v_exp_f32 v86, v86
    v_mfma_f32_16x16x32_bf16 v[104:107], a[148:151], a[100:103], v[104:107]
    ds_read_b128 a[176:179], v238 offset:17664
    v_cvt_pk_bf16_f32 v174, v140, v141
    v_mfma_f32_16x16x32_bf16 v[104:107], a[144:147], a[96:99], v[104:107]
    v_exp_f32 v87, v87
    v_mfma_f32_16x16x32_bf16 v[100:103], a[144:147], a[80:83], v[212:215]
    global_load_lds_dwordx4 v2, s[18:19] offset:-928 nt
    v_mfma_f32_16x16x32_bf16 v[100:103], a[148:151], a[84:87], v[100:103]
    v_exp_f32 v88, v88
    v_mfma_f32_16x16x32_bf16 v[100:103], a[152:155], a[88:91], v[100:103]
    v_exp_f32 v89, v89
    v_mfma_f32_16x16x32_bf16 v[100:103], a[156:159], a[92:95], v[100:103]
    ds_read_b128 a[180:183], v238 offset:17728
    v_cvt_pk_bf16_f32 v175, v142, v143
    v_mfma_f32_16x16x32_bf16 v[96:99], a[156:159], a[76:79], v[208:211]
    v_exp_f32 v90, v90
    v_mfma_f32_16x16x32_bf16 v[96:99], a[152:155], a[72:75], v[96:99]
    v_exp_f32 v91, v91
    v_mfma_f32_16x16x32_bf16 v[96:99], a[148:151], a[68:71], v[96:99]
    v_exp_f32 v92, v92
    v_mfma_f32_16x16x32_bf16 v[96:99], a[144:147], a[64:67], v[96:99]
    s_waitcnt lgkmcnt(2)
    global_load_lds_dwordx4 v3, s[18:19] offset:128 nt
    v_mfma_f32_16x16x32_bf16 v[112:115], a[160:163], a[64:67], v[208:211]
    ds_read_b128 a[184:187], v238 offset:17792
    v_mfma_f32_16x16x32_bf16 v[112:115], a[164:167], a[68:71], v[112:115]
    v_exp_f32 v93, v93
    v_mfma_f32_16x16x32_bf16 v[112:115], a[168:171], a[72:75], v[112:115]
    ds_read_b128 a[188:191], v238 offset:17856
    v_cvt_pk_bf16_f32 v176, v80, v81
    v_mfma_f32_16x16x32_bf16 v[112:115], a[172:175], a[76:79], v[112:115]
    v_exp_f32 v94, v94
    v_mfma_f32_16x16x32_bf16 v[116:119], a[172:175], a[92:95], v[212:215]
    v_exp_f32 v95, v95
    v_mfma_f32_16x16x32_bf16 v[116:119], a[168:171], a[88:91], v[116:119]
    global_load_lds_dwordx4 v4, s[18:19] offset:1184 nt
    v_mfma_f32_16x16x32_bf16 v[116:119], a[164:167], a[84:87], v[116:119]
    v_exp_f32 v96, v96
    v_mfma_f32_16x16x32_bf16 v[116:119], a[160:163], a[80:83], v[116:119]
    v_exp_f32 v97, v97
    v_mfma_f32_16x16x32_bf16 v[120:123], a[160:163], a[96:99], v[216:219]
    v_exp_f32 v98, v98
    v_mfma_f32_16x16x32_bf16 v[120:123], a[164:167], a[100:103], v[120:123]
    v_exp_f32 v99, v99
    v_mfma_f32_16x16x32_bf16 v[120:123], a[168:171], a[104:107], v[120:123]
    v_exp_f32 v100, v100
    v_mfma_f32_16x16x32_bf16 v[120:123], a[172:175], a[108:111], v[120:123]
    s_waitcnt vmcnt(14) lgkmcnt(0)
    v_exp_f32 v101, v101
    v_mfma_f32_16x16x32_bf16 v[124:127], a[172:175], a[124:127], v[220:223]
    s_barrier
    v_mfma_f32_16x16x32_bf16 v[124:127], a[168:171], a[120:123], v[124:127]
    v_exp_f32 v102, v102
    v_mfma_f32_16x16x32_bf16 v[124:127], a[164:167], a[116:119], v[124:127]
    global_load_lds_dwordx4 v5, s[18:19] offset:2240 nt
    v_mfma_f32_16x16x32_bf16 v[124:127], a[160:163], a[112:115], v[124:127]
    ds_read_b64_tr_b16 a[192:193], v239 offset:33792
    v_mfma_f32_16x16x32_bf16 v[140:143], a[176:179], a[112:115], v[220:223]
    v_exp_f32 v103, v103
    v_mfma_f32_16x16x32_bf16 v[140:143], a[180:183], a[116:119], v[140:143]
    ds_read_b64_tr_b16 a[194:195], v239 offset:34048
    v_cvt_pk_bf16_f32 v177, v82, v83
    v_mfma_f32_16x16x32_bf16 v[140:143], a[184:187], a[120:123], v[140:143]
    ds_read_b64_tr_b16 a[196:197], v239 offset:34304
    v_cvt_pk_bf16_f32 v184, v84, v85
    v_mfma_f32_16x16x32_bf16 v[140:143], a[188:191], a[124:127], v[140:143]
    v_exp_f32 v104, v104
    v_mfma_f32_16x16x32_bf16 v[136:139], a[188:191], a[108:111], v[216:219]
    v_exp_f32 v105, v105
    v_mfma_f32_16x16x32_bf16 v[136:139], a[184:187], a[104:107], v[136:139]
    global_load_lds_dwordx4 v6, s[18:19] offset:3296 nt
    v_mfma_f32_16x16x32_bf16 v[136:139], a[180:183], a[100:103], v[136:139]
    s_add_u32 s18, s18, s26
    ds_read_b64_tr_b16 a[198:199], v239 offset:34560
    v_mfma_f32_16x16x32_bf16 v[136:139], a[176:179], a[96:99], v[136:139]
    s_addc_u32 s19, s19, 0
    ds_read_b64_tr_b16 a[200:201], v239 offset:33824
    v_cvt_pk_bf16_f32 v185, v86, v87
    v_mfma_f32_16x16x32_bf16 v[132:135], a[176:179], a[80:83], v[212:215]
    ds_read_b64_tr_b16 a[202:203], v239 offset:34080
    v_cvt_pk_bf16_f32 v192, v88, v89
    v_mfma_f32_16x16x32_bf16 v[132:135], a[180:183], a[84:87], v[132:135]
    ds_read_b64_tr_b16 a[204:205], v239 offset:34336
    v_cvt_pk_bf16_f32 v193, v90, v91
    v_mfma_f32_16x16x32_bf16 v[132:135], a[184:187], a[88:91], v[132:135]
    v_exp_f32 v106, v106
    v_mfma_f32_16x16x32_bf16 v[132:135], a[188:191], a[92:95], v[132:135]
    ds_read_b64_tr_b16 a[206:207], v239 offset:34592
    v_cvt_pk_bf16_f32 v200, v92, v93
    v_mfma_f32_16x16x32_bf16 v[128:131], a[188:191], a[76:79], v[208:211]
    s_add_u32 m0, s24, 20992
    v_exp_f32 v107, v107
    v_mfma_f32_16x16x32_bf16 v[128:131], a[184:187], a[72:75], v[128:131]
    global_load_lds_dwordx4 v241, s[16:17] offset:-4096 nt
    v_mfma_f32_16x16x32_bf16 v[128:131], a[180:183], a[68:71], v[128:131]
    ds_read_b64_tr_b16 a[208:209], v239 offset:33856
    v_mfma_f32_16x16x32_bf16 v[128:131], a[176:179], a[64:67], v[128:131]
    ds_read_b64_tr_b16 a[210:211], v239 offset:34112
    v_cvt_pk_bf16_f32 v201, v94, v95
    v_smfmac_f32_16x16x64_bf16 v[232:235], v[224:227], v[160:167], v243
    ds_read_b64_tr_b16 a[212:213], v239 offset:34368
    v_smfmac_f32_16x16x64_bf16 v[232:235], v[252:255], v[168:175], v243
    ds_read_b64_tr_b16 a[214:215], v239 offset:34624
    v_smfmac_f32_16x16x64_bf16 v[228:231], v[252:255], v[152:159], v243
    ds_read_b64_tr_b16 a[216:217], v239 offset:33888
    v_smfmac_f32_16x16x64_bf16 v[228:231], v[224:227], v[144:151], v243
    s_waitcnt lgkmcnt(5)
    ds_read_b64_tr_b16 a[218:219], v239 offset:34144
    v_mfma_f32_16x16x32_bf16 v[16:19], v[144:147], a[192:195], v[16:19]
    v_exp_f32 v108, v108
    v_mfma_f32_16x16x32_bf16 v[16:19], v[148:151], a[196:199], v[16:19]
    global_load_lds_dwordx4 v0, s[16:17] offset:-3040 nt
    v_mfma_f32_16x16x32_bf16 v[20:23], v[148:151], a[204:207], v[20:23]
    v_exp_f32 v109, v109
    v_mfma_f32_16x16x32_bf16 v[20:23], v[144:147], a[200:203], v[20:23]
    v_exp_f32 v110, v110
    v_mfma_f32_16x16x32_bf16 v[52:55], v[152:155], a[200:203], v[52:55]
    ds_read_b64_tr_b16 a[220:221], v239 offset:34400
    v_cvt_pk_bf16_f32 v178, v96, v97
    v_mfma_f32_16x16x32_bf16 v[52:55], v[156:159], a[204:207], v[52:55]
    v_exp_f32 v111, v111
    v_mfma_f32_16x16x32_bf16 v[48:51], v[156:159], a[196:199], v[48:51]
    ds_read_b64_tr_b16 a[222:223], v239 offset:34656
    v_cvt_pk_bf16_f32 v179, v98, v99
    v_mfma_f32_16x16x32_bf16 v[48:51], v[152:155], a[192:195], v[48:51]
    v_exp_f32 v112, v112
    v_mfma_f32_16x16x32_bf16 a[0:3], v[160:163], a[192:195], a[0:3]
    global_load_lds_dwordx4 v1, s[16:17] offset:-1984 nt
    v_mfma_f32_16x16x32_bf16 a[0:3], v[164:167], a[196:199], a[0:3]
    ds_read_b64_tr_b16 a[224:225], v239 offset:33920
    v_mfma_f32_16x16x32_bf16 a[8:11], v[164:167], a[204:207], a[8:11]
    ds_read_b64_tr_b16 a[226:227], v239 offset:34176
    v_cvt_pk_bf16_f32 v186, v100, v101
    v_mfma_f32_16x16x32_bf16 a[8:11], v[160:163], a[200:203], a[8:11]
    v_exp_f32 v113, v113
    v_mfma_f32_16x16x32_bf16 a[12:15], v[168:171], a[200:203], a[12:15]
    ds_read_b64_tr_b16 a[228:229], v239 offset:34432
    v_cvt_pk_bf16_f32 v187, v102, v103
    v_mfma_f32_16x16x32_bf16 a[12:15], v[172:175], a[204:207], a[12:15]
    ds_read_b64_tr_b16 a[230:231], v239 offset:34688
    v_cvt_pk_bf16_f32 v194, v104, v105
    v_mfma_f32_16x16x32_bf16 a[4:7], v[172:175], a[196:199], a[4:7]
    ds_read_b64_tr_b16 a[232:233], v239 offset:33952
    v_cvt_pk_bf16_f32 v195, v106, v107
    v_mfma_f32_16x16x32_bf16 a[4:7], v[168:171], a[192:195], a[4:7]
    s_waitcnt lgkmcnt(5)
    v_exp_f32 v114, v114
    v_mfma_f32_16x16x32_bf16 a[20:23], v[168:171], a[208:211], a[20:23]
    global_load_lds_dwordx4 v2, s[16:17] offset:-928 nt
    v_mfma_f32_16x16x32_bf16 a[20:23], v[172:175], a[212:215], a[20:23]
    ds_read_b64_tr_b16 a[234:235], v239 offset:34208
    v_mfma_f32_16x16x32_bf16 a[28:31], v[172:175], a[220:223], a[28:31]
    v_exp_f32 v115, v115
    v_mfma_f32_16x16x32_bf16 a[28:31], v[168:171], a[216:219], a[28:31]
    ds_read_b64_tr_b16 a[236:237], v239 offset:34464
    v_cvt_pk_bf16_f32 v202, v108, v109
    v_mfma_f32_16x16x32_bf16 a[24:27], v[160:163], a[216:219], a[24:27]
    ds_read_b64_tr_b16 a[238:239], v239 offset:34720
    v_cvt_pk_bf16_f32 v203, v110, v111
    v_mfma_f32_16x16x32_bf16 a[24:27], v[164:167], a[220:223], a[24:27]
    v_exp_f32 v116, v116
    v_mfma_f32_16x16x32_bf16 a[16:19], v[164:167], a[212:215], a[16:19]
    v_exp_f32 v117, v117
    v_mfma_f32_16x16x32_bf16 a[16:19], v[160:163], a[208:211], a[16:19]
    global_load_lds_dwordx4 v3, s[16:17] offset:128 nt
    v_mfma_f32_16x16x32_bf16 v[56:59], v[152:155], a[208:211], v[56:59]
    ds_read_b64_tr_b16 a[240:241], v239 offset:33984
    v_mfma_f32_16x16x32_bf16 v[56:59], v[156:159], a[212:215], v[56:59]
    ds_read_b64_tr_b16 a[242:243], v239 offset:34240
    v_cvt_pk_bf16_f32 v180, v112, v113
    v_mfma_f32_16x16x32_bf16 v[60:63], v[156:159], a[220:223], v[60:63]
    ds_read_b64_tr_b16 a[244:245], v239 offset:34496
    v_cvt_pk_bf16_f32 v181, v114, v115
    v_mfma_f32_16x16x32_bf16 v[60:63], v[152:155], a[216:219], v[60:63]
    v_exp_f32 v118, v118
    v_mfma_f32_16x16x32_bf16 v[28:31], v[144:147], a[216:219], v[28:31]
    ds_read_b64_tr_b16 a[246:247], v239 offset:34752
    v_cvt_pk_bf16_f32 v188, v116, v117
    v_mfma_f32_16x16x32_bf16 v[28:31], v[148:151], a[220:223], v[28:31]
    v_exp_f32 v119, v119
    v_mfma_f32_16x16x32_bf16 v[24:27], v[148:151], a[212:215], v[24:27]
    global_load_lds_dwordx4 v4, s[16:17] offset:1184 nt
    v_mfma_f32_16x16x32_bf16 v[24:27], v[144:147], a[208:211], v[24:27]
    s_waitcnt lgkmcnt(4)
    ds_read_b64_tr_b16 a[248:249], v239 offset:34016
    v_mfma_f32_16x16x32_bf16 v[32:35], v[144:147], a[224:227], v[32:35]
    ds_read_b64_tr_b16 a[250:251], v239 offset:34272
    v_cvt_pk_bf16_f32 v189, v118, v119
    v_mfma_f32_16x16x32_bf16 v[32:35], v[148:151], a[228:231], v[32:35]
    v_exp_f32 v120, v120
    v_mfma_f32_16x16x32_bf16 v[36:39], v[148:151], a[236:239], v[36:39]
    ds_read_b64_tr_b16 a[252:253], v239 offset:34528
    v_mfma_f32_16x16x32_bf16 v[36:39], v[144:147], a[232:235], v[36:39]
    ds_read_b64_tr_b16 a[254:255], v239 offset:34784
    v_mfma_f32_16x16x32_bf16 v[68:71], v[152:155], a[232:235], v[68:71]
    v_exp_f32 v121, v121
    v_mfma_f32_16x16x32_bf16 v[68:71], v[156:159], a[236:239], v[68:71]
    v_exp_f32 v122, v122
    v_mfma_f32_16x16x32_bf16 v[64:67], v[156:159], a[228:231], v[64:67]
    global_load_lds_dwordx4 v5, s[16:17] offset:2240 nt
    v_mfma_f32_16x16x32_bf16 v[64:67], v[152:155], a[224:227], v[64:67]
    v_exp_f32 v123, v123
    v_mfma_f32_16x16x32_bf16 a[32:35], v[160:163], a[224:227], a[32:35]
    v_exp_f32 v124, v124
    v_mfma_f32_16x16x32_bf16 a[32:35], v[164:167], a[228:231], a[32:35]
    s_waitcnt vmcnt(15) lgkmcnt(0)
    v_exp_f32 v125, v125
    v_mfma_f32_16x16x32_bf16 a[40:43], v[164:167], a[236:239], a[40:43]
    s_barrier
    v_mfma_f32_16x16x32_bf16 a[40:43], v[160:163], a[232:235], a[40:43]
L_pad1:
    s_cbranch_execz L_x
    v_mfma_f32_16x16x32_bf16 a[44:47], v[168:171], a[232:235], a[44:47]
    v_exp_f32 v126, v126
    v_mfma_f32_16x16x32_bf16 a[44:47], v[172:175], a[236:239], a[44:47]
    v_exp_f32 v127, v127
    v_mfma_f32_16x16x32_bf16 a[36:39], v[172:175], a[228:231], a[36:39]
    global_load_lds_dwordx4 v6, s[16:17] offset:3296 nt
    v_mfma_f32_16x16x32_bf16 a[36:39], v[168:171], a[224:227], a[36:39]
    s_add_u32 s16, s16, s26
    v_exp_f32 v128, v128
    v_mfma_f32_16x16x32_bf16 a[52:55], v[168:171], a[240:243], a[52:55]
    s_addc_u32 s17, s17, 0
    v_exp_f32 v129, v129
    v_mfma_f32_16x16x32_bf16 a[52:55], v[172:175], a[244:247], a[52:55]
    s_add_u32 s25, s25, 1
    ds_read_b128 a[128:131], v238 offset:0
    v_cvt_pk_bf16_f32 v196, v120, v121
    v_mfma_f32_16x16x32_bf16 a[60:63], v[172:175], a[252:255], a[60:63]
    s_cselect_b64 s[16:17], s[2:3], s[16:17]
    v_exp_f32 v130, v130
    v_mfma_f32_16x16x32_bf16 a[60:63], v[168:171], a[248:251], a[60:63]
    v_exp_f32 v131, v131
    v_mfma_f32_16x16x32_bf16 a[56:59], v[160:163], a[248:251], a[56:59]
    ds_read_b128 a[132:135], v238 offset:64
    v_cvt_pk_bf16_f32 v197, v122, v123
    v_mfma_f32_16x16x32_bf16 a[56:59], v[164:167], a[252:255], a[56:59]
    v_exp_f32 v132, v132
    v_mfma_f32_16x16x32_bf16 a[48:51], v[164:167], a[244:247], a[48:51]
    ds_read_b128 a[136:139], v238 offset:128
    v_cvt_pk_bf16_f32 v204, v124, v125
    v_mfma_f32_16x16x32_bf16 a[48:51], v[160:163], a[240:243], a[48:51]
    v_exp_f32 v133, v133
    v_mfma_f32_16x16x32_bf16 v[72:75], v[152:155], a[240:243], v[72:75]
    ds_read_b128 a[140:143], v238 offset:192
    v_cvt_pk_bf16_f32 v205, v126, v127
    v_mfma_f32_16x16x32_bf16 v[72:75], v[156:159], a[244:247], v[72:75]
    v_exp_f32 v134, v134
    v_mfma_f32_16x16x32_bf16 v[76:79], v[156:159], a[252:255], v[76:79]
    v_exp_f32 v135, v135
    v_mfma_f32_16x16x32_bf16 v[76:79], v[152:155], a[248:251], v[76:79]
    ds_read_b128 a[144:147], v238 offset:256
    v_cvt_pk_bf16_f32 v182, v128, v129
    v_mfma_f32_16x16x32_bf16 v[44:47], v[144:147], a[248:251], v[44:47]
    v_exp_f32 v136, v136
    v_mfma_f32_16x16x32_bf16 v[44:47], v[148:151], a[252:255], v[44:47]
    ds_read_b128 a[148:151], v238 offset:320
    v_cvt_pk_bf16_f32 v183, v130, v131
    v_mfma_f32_16x16x32_bf16 v[40:43], v[148:151], a[244:247], v[40:43]
    s_waitcnt lgkmcnt(2)
    v_exp_f32 v137, v137
    v_mfma_f32_16x16x32_bf16 v[40:43], v[144:147], a[240:243], v[40:43]
    v_mfma_f32_16x16x32_bf16 v[80:83], a[128:131], a[64:67], v[208:211]
    v_exp_f32 v138, v138
    v_mfma_f32_16x16x32_bf16 v[80:83], a[132:135], a[68:71], v[80:83]
    s_add_u32 m0, s24, 37888
    v_exp_f32 v139, v139
    v_mfma_f32_16x16x32_bf16 v[80:83], a[136:139], a[72:75], v[80:83]
    global_load_lds_dwordx4 v241, s[18:19] offset:-4096 nt
    v_mfma_f32_16x16x32_bf16 v[80:83], a[140:143], a[76:79], v[80:83]
    ds_read_b128 a[152:155], v238 offset:384
    v_mfma_f32_16x16x32_bf16 v[84:87], a[140:143], a[92:95], v[212:215]
    v_exp_f32 v140, v140
    v_mfma_f32_16x16x32_bf16 v[84:87], a[136:139], a[88:91], v[84:87]
    ds_read_b128 a[156:159], v238 offset:448
    v_cvt_pk_bf16_f32 v190, v132, v133
    v_mfma_f32_16x16x32_bf16 v[84:87], a[132:135], a[84:87], v[84:87]
    v_exp_f32 v141, v141
    v_mfma_f32_16x16x32_bf16 v[84:87], a[128:131], a[80:83], v[84:87]
    v_exp_f32 v142, v142
    v_mfma_f32_16x16x32_bf16 v[88:91], a[128:131], a[96:99], v[216:219]
    v_exp_f32 v143, v143
    v_mfma_f32_16x16x32_bf16 v[88:91], a[132:135], a[100:103], v[88:91]
    global_load_lds_dwordx4 v0, s[18:19] offset:-3040 nt
    v_mfma_f32_16x16x32_bf16 v[88:91], a[136:139], a[104:107], v[88:91]
    ds_read_b128 a[160:163], v238 offset:512
    v_mfma_f32_16x16x32_bf16 v[88:91], a[140:143], a[108:111], v[88:91]
    v_exp_f32 v80, v80
    v_mfma_f32_16x16x32_bf16 v[92:95], a[140:143], a[124:127], v[220:223]
    v_exp_f32 v81, v81
    v_mfma_f32_16x16x32_bf16 v[92:95], a[136:139], a[120:123], v[92:95]
    ds_read_b128 a[164:167], v238 offset:576
    v_cvt_pk_bf16_f32 v191, v134, v135
    v_mfma_f32_16x16x32_bf16 v[92:95], a[132:135], a[116:119], v[92:95]
    v_exp_f32 v82, v82
    v_mfma_f32_16x16x32_bf16 v[92:95], a[128:131], a[112:115], v[92:95]
    s_waitcnt lgkmcnt(2)
    v_exp_f32 v83, v83
    v_mfma_f32_16x16x32_bf16 v[108:111], a[144:147], a[112:115], v[220:223]
    global_load_lds_dwordx4 v1, s[18:19] offset:-1984 nt
    v_mfma_f32_16x16x32_bf16 v[108:111], a[148:151], a[116:119], v[108:111]
    v_exp_f32 v84, v84
    v_mfma_f32_16x16x32_bf16 v[108:111], a[152:155], a[120:123], v[108:111]
    ds_read_b128 a[168:171], v238 offset:640
    v_cvt_pk_bf16_f32 v198, v136, v137
    v_mfma_f32_16x16x32_bf16 v[108:111], a[156:159], a[124:127], v[108:111]
    v_exp_f32 v85, v85
    v_mfma_f32_16x16x32_bf16 v[104:107], a[156:159], a[108:111], v[216:219]
    ds_read_b128 a[172:175], v238 offset:704
    v_cvt_pk_bf16_f32 v199, v138, v139
    v_mfma_f32_16x16x32_bf16 v[104:107], a[152:155], a[104:107], v[104:107]
    v_exp_f32 v86, v86
    v_mfma_f32_16x16x32_bf16 v[104:107], a[148:151], a[100:103], v[104:107]
    ds_read_b128 a[176:179], v238 offset:768
    v_cvt_pk_bf16_f32 v206, v140, v141
    v_mfma_f32_16x16x32_bf16 v[104:107], a[144:147], a[96:99], v[104:107]
    v_exp_f32 v87, v87
    v_mfma_f32_16x16x32_bf16 v[100:103], a[144:147], a[80:83], v[212:215]
    global_load_lds_dwordx4 v2, s[18:19] offset:-928 nt
    v_mfma_f32_16x16x32_bf16 v[100:103], a[148:151], a[84:87], v[100:103]
    v_exp_f32 v88, v88
    v_mfma_f32_16x16x32_bf16 v[100:103], a[152:155], a[88:91], v[100:103]
    v_exp_f32 v89, v89
    v_mfma_f32_16x16x32_bf16 v[100:103], a[156:159], a[92:95], v[100:103]
    ds_read_b128 a[180:183], v238 offset:832
    v_cvt_pk_bf16_f32 v207, v142, v143
    v_mfma_f32_16x16x32_bf16 v[96:99], a[156:159], a[76:79], v[208:211]
    v_exp_f32 v90, v90
    v_mfma_f32_16x16x32_bf16 v[96:99], a[152:155], a[72:75], v[96:99]
    v_exp_f32 v91, v91
    v_mfma_f32_16x16x32_bf16 v[96:99], a[148:151], a[68:71], v[96:99]
    v_exp_f32 v92, v92
    v_mfma_f32_16x16x32_bf16 v[96:99], a[144:147], a[64:67], v[96:99]
    s_waitcnt lgkmcnt(2)
    global_load_lds_dwordx4 v3, s[18:19] offset:128 nt
    v_mfma_f32_16x16x32_bf16 v[112:115], a[160:163], a[64:67], v[208:211]
    ds_read_b128 a[184:187], v238 offset:896
    v_mfma_f32_16x16x32_bf16 v[112:115], a[164:167], a[68:71], v[112:115]
    v_exp_f32 v93, v93
    v_mfma_f32_16x16x32_bf16 v[112:115], a[168:171], a[72:75], v[112:115]
    ds_read_b128 a[188:191], v238 offset:960
    v_cvt_pk_bf16_f32 v144, v80, v81
    v_mfma_f32_16x16x32_bf16 v[112:115], a[172:175], a[76:79], v[112:115]
    v_exp_f32 v94, v94
    v_mfma_f32_16x16x32_bf16 v[116:119], a[172:175], a[92:95], v[212:215]
    v_exp_f32 v95, v95
    v_mfma_f32_16x16x32_bf16 v[116:119], a[168:171], a[88:91], v[116:119]
    global_load_lds_dwordx4 v4, s[18:19] offset:1184 nt
    v_mfma_f32_16x16x32_bf16 v[116:119], a[164:167], a[84:87], v[116:119]
    v_exp_f32 v96, v96
    v_mfma_f32_16x16x32_bf16 v[116:119], a[160:163], a[80:83], v[116:119]
    v_exp_f32 v97, v97
    v_mfma_f32_16x16x32_bf16 v[120:123], a[160:163], a[96:99], v[216:219]
    v_exp_f32 v98, v98
    v_mfma_f32_16x16x32_bf16 v[120:123], a[164:167], a[100:103], v[120:123]
    v_exp_f32 v99, v99
    v_mfma_f32_16x16x32_bf16 v[120:123], a[168:171], a[104:107], v[120:123]
    v_exp_f32 v100, v100
    v_mfma_f32_16x16x32_bf16 v[120:123], a[172:175], a[108:111], v[120:123]
    s_waitcnt vmcnt(14) lgkmcnt(0)
    v_exp_f32 v101, v101
    v_mfma_f32_16x16x32_bf16 v[124:127], a[172:175], a[124:127], v[220:223]
    s_barrier
    v_mfma_f32_16x16x32_bf16 v[124:127], a[168:171], a[120:123], v[124:127]
    v_exp_f32 v102, v102
    v_mfma_f32_16x16x32_bf16 v[124:127], a[164:167], a[116:119], v[124:127]
    global_load_lds_dwordx4 v5, s[18:19] offset:2240 nt
    v_mfma_f32_16x16x32_bf16 v[124:127], a[160:163], a[112:115], v[124:127]
    ds_read_b64_tr_b16 a[192:193], v239 offset:50688
    v_mfma_f32_16x16x32_bf16 v[140:143], a[176:179], a[112:115], v[220:223]
    v_exp_f32 v103, v103
    v_mfma_f32_16x16x32_bf16 v[140:143], a[180:183], a[116:119], v[140:143]
    ds_read_b64_tr_b16 a[194:195], v239 offset:50944
    v_cvt_pk_bf16_f32 v145, v82, v83
    v_mfma_f32_16x16x32_bf16 v[140:143], a[184:187], a[120:123], v[140:143]
    ds_read_b64_tr_b16 a[196:197], v239 offset:51200
    v_cvt_pk_bf16_f32 v152, v84, v85
    v_mfma_f32_16x16x32_bf16 v[140:143], a[188:191], a[124:127], v[140:143]
    v_exp_f32 v104, v104
    v_mfma_f32_16x16x32_bf16 v[136:139], a[188:191], a[108:111], v[216:219]
    v_exp_f32 v105, v105
    v_mfma_f32_16x16x32_bf16 v[136:139], a[184:187], a[104:107], v[136:139]
    global_load_lds_dwordx4 v6, s[18:19] offset:3296 nt
    v_mfma_f32_16x16x32_bf16 v[136:139], a[180:183], a[100:103], v[136:139]
    s_add_u32 s18, s18, s26
    ds_read_b64_tr_b16 a[198:199], v239 offset:51456
    v_mfma_f32_16x16x32_bf16 v[136:139], a[176:179], a[96:99], v[136:139]
    s_addc_u32 s19, s19, 0
    ds_read_b64_tr_b16 a[200:201], v239 offset:50720
    v_cvt_pk_bf16_f32 v153, v86, v87
    v_mfma_f32_16x16x32_bf16 v[132:135], a[176:179], a[80:83], v[212:215]
    ds_read_b64_tr_b16 a[202:203], v239 offset:50976
    v_cvt_pk_bf16_f32 v160, v88, v89
    v_mfma_f32_16x16x32_bf16 v[132:135], a[180:183], a[84:87], v[132:135]
    ds_read_b64_tr_b16 a[204:205], v239 offset:51232
    v_cvt_pk_bf16_f32 v161, v90, v91
    v_mfma_f32_16x16x32_bf16 v[132:135], a[184:187], a[88:91], v[132:135]
    v_exp_f32 v106, v106
    v_mfma_f32_16x16x32_bf16 v[132:135], a[188:191], a[92:95], v[132:135]
    ds_read_b64_tr_b16 a[206:207], v239 offset:51488
    v_cvt_pk_bf16_f32 v168, v92, v93
    v_mfma_f32_16x16x32_bf16 v[128:131], a[188:191], a[76:79], v[208:211]
    s_add_u32 m0, s24, 4096
    v_exp_f32 v107, v107
    v_mfma_f32_16x16x32_bf16 v[128:131], a[184:187], a[72:75], v[128:131]
    global_load_lds_dwordx4 v241, s[16:17] offset:-4096 nt
    v_mfma_f32_16x16x32_bf16 v[128:131], a[180:183], a[68:71], v[128:131]
    ds_read_b64_tr_b16 a[208:209], v239 offset:50752
    v_mfma_f32_16x16x32_bf16 v[128:131], a[176:179], a[64:67], v[128:131]
    ds_read_b64_tr_b16 a[210:211], v239 offset:51008
    v_cvt_pk_bf16_f32 v169, v94, v95
    v_smfmac_f32_16x16x64_bf16 v[232:235], v[224:227], v[192:199], v243
    ds_read_b64_tr_b16 a[212:213], v239 offset:51264
    v_smfmac_f32_16x16x64_bf16 v[232:235], v[252:255], v[200:207], v243
    ds_read_b64_tr_b16 a[214:215], v239 offset:51520
    v_smfmac_f32_16x16x64_bf16 v[228:231], v[252:255], v[184:191], v243
    ds_read_b64_tr_b16 a[216:217], v239 offset:50784
    v_smfmac_f32_16x16x64_bf16 v[228:231], v[224:227], v[176:183], v243
    s_waitcnt lgkmcnt(5)
    ds_read_b64_tr_b16 a[218:219], v239 offset:51040
    v_mfma_f32_16x16x32_bf16 v[16:19], v[176:179], a[192:195], v[16:19]
    v_exp_f32 v108, v108
    v_mfma_f32_16x16x32_bf16 v[16:19], v[180:183], a[196:199], v[16:19]
    global_load_lds_dwordx4 v0, s[16:17] offset:-3040 nt
    v_mfma_f32_16x16x32_bf16 v[20:23], v[180:183], a[204:207], v[20:23]
    v_exp_f32 v109, v109
    v_mfma_f32_16x16x32_bf16 v[20:23], v[176:179], a[200:203], v[20:23]
    v_exp_f32 v110, v110
    v_mfma_f32_16x16x32_bf16 v[52:55], v[184:187], a[200:203], v[52:55]
    ds_read_b64_tr_b16 a[220:221], v239 offset:51296
    v_cvt_pk_bf16_f32 v146, v96, v97
    v_mfma_f32_16x16x32_bf16 v[52:55], v[188:191], a[204:207], v[52:55]
    v_exp_f32 v111, v111
    v_mfma_f32_16x16x32_bf16 v[48:51], v[188:191], a[196:199], v[48:51]
    ds_read_b64_tr_b16 a[222:223], v239 offset:51552
    v_cvt_pk_bf16_f32 v147, v98, v99
    v_mfma_f32_16x16x32_bf16 v[48:51], v[184:187], a[192:195], v[48:51]
    v_exp_f32 v112, v112
    v_mfma_f32_16x16x32_bf16 a[0:3], v[192:195], a[192:195], a[0:3]
    global_load_lds_dwordx4 v1, s[16:17] offset:-1984 nt
    v_mfma_f32_16x16x32_bf16 a[0:3], v[196:199], a[196:199], a[0:3]
    ds_read_b64_tr_b16 a[224:225], v239 offset:50816
    v_mfma_f32_16x16x32_bf16 a[8:11], v[196:199], a[204:207], a[8:11]
    ds_read_b64_tr_b16 a[226:227], v239 offset:51072
    v_cvt_pk_bf16_f32 v154, v100, v101
    v_mfma_f32_16x16x32_bf16 a[8:11], v[192:195], a[200:203], a[8:11]
    v_exp_f32 v113, v113
    v_mfma_f32_16x16x32_bf16 a[12:15], v[200:203], a[200:203], a[12:15]
    ds_read_b64_tr_b16 a[228:229], v239 offset:51328
    v_cvt_pk_bf16_f32 v155, v102, v103
    v_mfma_f32_16x16x32_bf16 a[12:15], v[204:207], a[204:207], a[12:15]
    ds_read_b64_tr_b16 a[230:231], v239 offset:51584
    v_cvt_pk_bf16_f32 v162, v104, v105
    v_mfma_f32_16x16x32_bf16 a[4:7], v[204:207], a[196:199], a[4:7]
    ds_read_b64_tr_b16 a[232:233], v239 offset:50848
    v_cvt_pk_bf16_f32 v163, v106, v107
    v_mfma_f32_16x16x32_bf16 a[4:7], v[200:203], a[192:195], a[4:7]
    s_waitcnt lgkmcnt(5)
    v_exp_f32 v114, v114
    v_mfma_f32_16x16x32_bf16 a[20:23], v[200:203], a[208:211], a[20:23]
    global_load_lds_dwordx4 v2, s[16:17] offset:-928 nt
    v_mfma_f32_16x16x32_bf16 a[20:23], v[204:207], a[212:215], a[20:23]
    ds_read_b64_tr_b16 a[234:235], v239 offset:51104
    v_mfma_f32_16x16x32_bf16 a[28:31], v[204:207], a[220:223], a[28:31]
    v_exp_f32 v115, v115
    v_mfma_f32_16x16x32_bf16 a[28:31], v[200:203], a[216:219], a[28:31]
    ds_read_b64_tr_b16 a[236:237], v239 offset:51360
    v_cvt_pk_bf16_f32 v170, v108, v109
    v_mfma_f32_16x16x32_bf16 a[24:27], v[192:195], a[216:219], a[24:27]
    ds_read_b64_tr_b16 a[238:239], v239 offset:51616
    v_cvt_pk_bf16_f32 v171, v110, v111
    v_mfma_f32_16x16x32_bf16 a[24:27], v[196:199], a[220:223], a[24:27]
    v_exp_f32 v116, v116
    v_mfma_f32_16x16x32_bf16 a[16:19], v[196:199], a[212:215], a[16:19]
    v_exp_f32 v117, v117
    v_mfma_f32_16x16x32_bf16 a[16:19], v[192:195], a[208:211], a[16:19]
    global_load_lds_dwordx4 v3, s[16:17] offset:128 nt
    v_mfma_f32_16x16x32_bf16 v[56:59], v[184:187], a[208:211], v[56:59]
    ds_read_b64_tr_b16 a[240:241], v239 offset:50880
    v_mfma_f32_16x16x32_bf16 v[56:59], v[188:191], a[212:215], v[56:59]
    ds_read_b64_tr_b16 a[242:243], v239 offset:51136
    v_cvt_pk_bf16_f32 v148, v112, v113
    v_mfma_f32_16x16x32_bf16 v[60:63], v[188:191], a[220:223], v[60:63]
    ds_read_b64_tr_b16 a[244:245], v239 offset:51392
    v_cvt_pk_bf16_f32 v149, v114, v115
    v_mfma_f32_16x16x32_bf16 v[60:63], v[184:187], a[216:219], v[60:63]
    v_exp_f32 v118, v118
    v_mfma_f32_16x16x32_bf16 v[28:31], v[176:179], a[216:219], v[28:31]
    ds_read_b64_tr_b16 a[246:247], v239 offset:51648
    v_cvt_pk_bf16_f32 v156, v116, v117
    v_mfma_f32_16x16x32_bf16 v[28:31], v[180:183], a[220:223], v[28:31]
    v_exp_f32 v119, v119
    v_mfma_f32_16x16x32_bf16 v[24:27], v[180:183], a[212:215], v[24:27]
    global_load_lds_dwordx4 v4, s[16:17] offset:1184 nt
    v_mfma_f32_16x16x32_bf16 v[24:27], v[176:179], a[208:211], v[24:27]
    s_waitcnt lgkmcnt(4)
    ds_read_b64_tr_b16 a[248:249], v239 offset:50912
    v_mfma_f32_16x16x32_bf16 v[32:35], v[176:179], a[224:227], v[32:35]
    ds_read_b64_tr_b16 a[250:251], v239 offset:51168
    v_cvt_pk_bf16_f32 v157, v118, v119
    v_mfma_f32_16x16x32_bf16 v[32:35], v[180:183], a[228:231], v[32:35]
    v_exp_f32 v120, v120
    v_mfma_f32_16x16x32_bf16 v[36:39], v[180:183], a[236:239], v[36:39]
    ds_read_b64_tr_b16 a[252:253], v239 offset:51424
    v_mfma_f32_16x16x32_bf16 v[36:39], v[176:179], a[232:235], v[36:39]
    ds_read_b64_tr_b16 a[254:255], v239 offset:51680
    v_mfma_f32_16x16x32_bf16 v[68:71], v[184:187], a[232:235], v[68:71]
    v_exp_f32 v121, v121
    v_mfma_f32_16x16x32_bf16 v[68:71], v[188:191], a[236:239], v[68:71]
    v_exp_f32 v122, v122
    v_mfma_f32_16x16x32_bf16 v[64:67], v[188:191], a[228:231], v[64:67]
    global_load_lds_dwordx4 v5, s[16:17] offset:2240 nt
    v_mfma_f32_16x16x32_bf16 v[64:67], v[184:187], a[224:227], v[64:67]
    v_exp_f32 v123, v123
    v_mfma_f32_16x16x32_bf16 a[32:35], v[192:195], a[224:227], a[32:35]
    v_exp_f32 v124, v124
    v_mfma_f32_16x16x32_bf16 a[32:35], v[196:199], a[228:231], a[32:35]
    s_waitcnt vmcnt(15) lgkmcnt(0)
    v_exp_f32 v125, v125
    v_mfma_f32_16x16x32_bf16 a[40:43], v[196:199], a[236:239], a[40:43]
    s_barrier
    v_mfma_f32_16x16x32_bf16 a[40:43], v[192:195], a[232:235], a[40:43]
    v_mfma_f32_16x16x32_bf16 a[44:47], v[200:203], a[232:235], a[44:47]
    v_exp_f32 v126, v126
    v_mfma_f32_16x16x32_bf16 a[44:47], v[204:207], a[236:239], a[44:47]
    v_exp_f32 v127, v127
    v_mfma_f32_16x16x32_bf16 a[36:39], v[204:207], a[228:231], a[36:39]
    global_load_lds_dwordx4 v6, s[16:17] offset:3296 nt
    v_mfma_f32_16x16x32_bf16 a[36:39], v[200:203], a[224:227], a[36:39]
    s_add_u32 s16, s16, s26
    v_exp_f32 v128, v128
    v_mfma_f32_16x16x32_bf16 a[52:55], v[200:203], a[240:243], a[52:55]
    s_addc_u32 s17, s17, 0
    v_exp_f32 v129, v129
    v_mfma_f32_16x16x32_bf16 a[52:55], v[204:207], a[244:247], a[52:55]
    ds_read_b128 a[128:131], v238 offset:16896
    v_cvt_pk_bf16_f32 v164, v120, v121
    v_mfma_f32_16x16x32_bf16 a[60:63], v[204:207], a[252:255], a[60:63]
    v_exp_f32 v130, v130
    v_mfma_f32_16x16x32_bf16 a[60:63], v[200:203], a[248:251], a[60:63]
    v_exp_f32 v131, v131
    v_mfma_f32_16x16x32_bf16 a[56:59], v[192:195], a[248:251], a[56:59]
    ds_read_b128 a[132:135], v238 offset:16960
    v_cvt_pk_bf16_f32 v165, v122, v123
    v_mfma_f32_16x16x32_bf16 a[56:59], v[196:199], a[252:255], a[56:59]
    v_exp_f32 v132, v132
    v_mfma_f32_16x16x32_bf16 a[48:51], v[196:199], a[244:247], a[48:51]
    ds_read_b128 a[136:139], v238 offset:17024
    v_cvt_pk_bf16_f32 v172, v124, v125
    v_mfma_f32_16x16x32_bf16 a[48:51], v[192:195], a[240:243], a[48:51]
    v_exp_f32 v133, v133
    v_mfma_f32_16x16x32_bf16 v[72:75], v[184:187], a[240:243], v[72:75]
    ds_read_b128 a[140:143], v238 offset:17088
    v_cvt_pk_bf16_f32 v173, v126, v127
    v_mfma_f32_16x16x32_bf16 v[72:75], v[188:191], a[244:247], v[72:75]
    v_exp_f32 v134, v134
    v_mfma_f32_16x16x32_bf16 v[76:79], v[188:191], a[252:255], v[76:79]
    v_exp_f32 v135, v135
    v_mfma_f32_16x16x32_bf16 v[76:79], v[184:187], a[248:251], v[76:79]
    ds_read_b128 a[144:147], v238 offset:17152
    v_cvt_pk_bf16_f32 v150, v128, v129
    v_mfma_f32_16x16x32_bf16 v[44:47], v[176:179], a[248:251], v[44:47]
    v_exp_f32 v136, v136
    v_mfma_f32_16x16x32_bf16 v[44:47], v[180:183], a[252:255], v[44:47]
    s_waitcnt lgkmcnt(1)
    ds_read_b128 a[148:151], v238 offset:17216
    v_cvt_pk_bf16_f32 v151, v130, v131
    v_mfma_f32_16x16x32_bf16 v[40:43], v[180:183], a[244:247], v[40:43]
    s_cmp_lg_u32 s25, 0
    v_exp_f32 v137, v137
    v_mfma_f32_16x16x32_bf16 v[40:43], v[176:179], a[240:243], v[40:43]
    s_cbranch_scc1 L_loop
L_tail:
    ds_read_b128 a[152:155], v238 offset:17280
    v_cvt_pk_bf16_f32 v158, v132, v133
    v_mfma_f32_16x16x32_bf16 v[88:91], a[128:131], a[96:99], v[216:219]
    ds_read_b128 a[156:159], v238 offset:17344
    v_cvt_pk_bf16_f32 v159, v134, v135
    v_mfma_f32_16x16x32_bf16 v[88:91], a[132:135], a[100:103], v[88:91]
    s_waitcnt lgkmcnt(2)
    v_exp_f32 v138, v138
    v_mfma_f32_16x16x32_bf16 v[88:91], a[136:139], a[104:107], v[88:91]
    ds_read_b128 a[160:163], v238 offset:17408
    v_cvt_pk_bf16_f32 v166, v136, v137
    v_mfma_f32_16x16x32_bf16 v[88:91], a[140:143], a[108:111], v[88:91]
    ds_read_b128 a[164:167], v238 offset:17472
    v_exp_f32 v139, v139
    v_mfma_f32_16x16x32_bf16 v[80:83], a[140:143], a[76:79], v[208:211]
    ds_read_b128 a[168:171], v238 offset:17536
    v_cvt_pk_bf16_f32 v167, v138, v139
    v_mfma_f32_16x16x32_bf16 v[80:83], a[136:139], a[72:75], v[80:83]
    ds_read_b128 a[172:175], v238 offset:17600
    v_exp_f32 v140, v140
    v_mfma_f32_16x16x32_bf16 v[80:83], a[132:135], a[68:71], v[80:83]
    ds_read_b128 a[176:179], v238 offset:17664
    v_exp_f32 v141, v141
    v_mfma_f32_16x16x32_bf16 v[80:83], a[128:131], a[64:67], v[80:83]
    ds_read_b128 a[180:183], v238 offset:17728
    v_cvt_pk_bf16_f32 v174, v140, v141
    v_mfma_f32_16x16x32_bf16 v[104:107], a[144:147], a[96:99], v[216:219]
    s_waitcnt lgkmcnt(5)
    ds_read_b128 a[184:187], v238 offset:17792
    v_exp_f32 v142, v142
    v_mfma_f32_16x16x32_bf16 v[104:107], a[148:151], a[100:103], v[104:107]
    ds_read_b128 a[188:191], v238 offset:17856
    v_exp_f32 v143, v143
    v_mfma_f32_16x16x32_bf16 v[104:107], a[152:155], a[104:107], v[104:107]
    v_exp_f32 v88, v88
    v_mfma_f32_16x16x32_bf16 v[104:107], a[156:159], a[108:111], v[104:107]
    v_exp_f32 v89, v89
    v_mfma_f32_16x16x32_bf16 v[96:99], a[156:159], a[76:79], v[208:211]
    v_exp_f32 v90, v90
    v_mfma_f32_16x16x32_bf16 v[96:99], a[152:155], a[72:75], v[96:99]
    s_waitcnt vmcnt(8)
    v_exp_f32 v91, v91
    v_mfma_f32_16x16x32_bf16 v[96:99], a[148:151], a[68:71], v[96:99]
    s_barrier
    v_mfma_f32_16x16x32_bf16 v[96:99], a[144:147], a[64:67], v[96:99]
    s_waitcnt lgkmcnt(0)
    ds_read_b64_tr_b16 a[192:193], v239 offset:33792
    v_cvt_pk_bf16_f32 v175, v142, v143
    v_mfma_f32_16x16x32_bf16 v[120:123], a[160:163], a[96:99], v[216:219]
    ds_read_b64_tr_b16 a[194:195], v239 offset:34048
    v_cvt_pk_bf16_f32 v192, v88, v89
    v_mfma_f32_16x16x32_bf16 v[120:123], a[164:167], a[100:103], v[120:123]
    v_exp_f32 v80, v80
    v_mfma_f32_16x16x32_bf16 v[120:123], a[168:171], a[104:107], v[120:123]
    ds_read_b64_tr_b16 a[196:197], v239 offset:34304
    v_cvt_pk_bf16_f32 v193, v90, v91
    v_mfma_f32_16x16x32_bf16 v[120:123], a[172:175], a[108:111], v[120:123]
    ds_read_b64_tr_b16 a[198:199], v239 offset:34560
    v_exp_f32 v81, v81
    v_mfma_f32_16x16x32_bf16 v[112:115], a[172:175], a[76:79], v[208:211]
    ds_read_b64_tr_b16 a[200:201], v239 offset:33824
    v_cvt_pk_bf16_f32 v176, v80, v81
    v_mfma_f32_16x16x32_bf16 v[112:115], a[168:171], a[72:75], v[112:115]
    v_exp_f32 v82, v82
    v_mfma_f32_16x16x32_bf16 v[112:115], a[164:167], a[68:71], v[112:115]
    ds_read_b64_tr_b16 a[202:203], v239 offset:34080
    v_exp_f32 v83, v83
    v_mfma_f32_16x16x32_bf16 v[112:115], a[160:163], a[64:67], v[112:115]
    ds_read_b64_tr_b16 a[204:205], v239 offset:34336
    v_cvt_pk_bf16_f32 v177, v82, v83
    v_mfma_f32_16x16x32_bf16 v[136:139], a[176:179], a[96:99], v[216:219]
    ds_read_b64_tr_b16 a[206:207], v239 offset:34592
    v_exp_f32 v104, v104
    v_mfma_f32_16x16x32_bf16 v[136:139], a[180:183], a[100:103], v[136:139]
    v_exp_f32 v105, v105
    v_mfma_f32_16x16x32_bf16 v[136:139], a[184:187], a[104:107], v[136:139]
    ds_read_b64_tr_b16 a[208:209], v239 offset:33856
    v_cvt_pk_bf16_f32 v194, v104, v105
    v_mfma_f32_16x16x32_bf16 v[136:139], a[188:191], a[108:111], v[136:139]
    ds_read_b64_tr_b16 a[210:211], v239 offset:34112
    v_exp_f32 v106, v106
    v_mfma_f32_16x16x32_bf16 v[128:131], a[188:191], a[76:79], v[208:211]
    ds_read_b64_tr_b16 a[212:213], v239 offset:34368
    v_exp_f32 v107, v107
    v_mfma_f32_16x16x32_bf16 v[128:131], a[184:187], a[72:75], v[128:131]
    v_exp_f32 v96, v96
    v_mfma_f32_16x16x32_bf16 v[128:131], a[180:183], a[68:71], v[128:131]
    ds_read_b64_tr_b16 a[214:215], v239 offset:34624
    v_cvt_pk_bf16_f32 v195, v106, v107
    v_mfma_f32_16x16x32_bf16 v[128:131], a[176:179], a[64:67], v[128:131]
    ds_read_b64_tr_b16 a[216:217], v239 offset:33888
    v_exp_f32 v97, v97
    v_mfma_f32_16x16x32_bf16 v[92:95], a[128:131], a[112:115], v[220:223]
    ds_read_b64_tr_b16 a[218:219], v239 offset:34144
    v_cvt_pk_bf16_f32 v178, v96, v97
    v_mfma_f32_16x16x32_bf16 v[92:95], a[132:135], a[116:119], v[92:95]
    v_exp_f32 v98, v98
    v_mfma_f32_16x16x32_bf16 v[92:95], a[136:139], a[120:123], v[92:95]
    ds_read_b64_tr_b16 a[220:221], v239 offset:34400
    v_exp_f32 v99, v99
    v_mfma_f32_16x16x32_bf16 v[92:95], a[140:143], a[124:127], v[92:95]
    ds_read_b64_tr_b16 a[222:223], v239 offset:34656
    v_cvt_pk_bf16_f32 v179, v98, v99
    v_mfma_f32_16x16x32_bf16 v[84:87], a[140:143], a[92:95], v[212:215]
    ds_read_b64_tr_b16 a[224:225], v239 offset:33920
    v_exp_f32 v120, v120
    v_mfma_f32_16x16x32_bf16 v[84:87], a[136:139], a[88:91], v[84:87]
    v_exp_f32 v121, v121
    v_mfma_f32_16x16x32_bf16 v[84:87], a[132:135], a[84:87], v[84:87]
    ds_read_b64_tr_b16 a[226:227], v239 offset:34176
    v_cvt_pk_bf16_f32 v196, v120, v121
    v_mfma_f32_16x16x32_bf16 v[84:87], a[128:131], a[80:83], v[84:87]
    ds_read_b64_tr_b16 a[228:229], v239 offset:34432
    v_exp_f32 v122, v122
    v_mfma_f32_16x16x32_bf16 v[108:111], a[144:147], a[112:115], v[220:223]
    ds_read_b64_tr_b16 a[230:231], v239 offset:34688
    v_exp_f32 v123, v123
    v_mfma_f32_16x16x32_bf16 v[108:111], a[148:151], a[116:119], v[108:111]
    v_exp_f32 v112, v112
    v_mfma_f32_16x16x32_bf16 v[108:111], a[152:155], a[120:123], v[108:111]
    ds_read_b64_tr_b16 a[232:233], v239 offset:33952
    v_cvt_pk_bf16_f32 v197, v122, v123
    v_mfma_f32_16x16x32_bf16 v[108:111], a[156:159], a[124:127], v[108:111]
    ds_read_b64_tr_b16 a[234:235], v239 offset:34208
    v_exp_f32 v113, v113
    v_mfma_f32_16x16x32_bf16 v[100:103], a[156:159], a[92:95], v[212:215]
    ds_read_b64_tr_b16 a[236:237], v239 offset:34464
    v_cvt_pk_bf16_f32 v180, v112, v113
    v_mfma_f32_16x16x32_bf16 v[100:103], a[152:155], a[88:91], v[100:103]
    v_exp_f32 v114, v114
    v_mfma_f32_16x16x32_bf16 v[100:103], a[148:151], a[84:87], v[100:103]
    ds_read_b64_tr_b16 a[238:239], v239 offset:34720
    v_exp_f32 v115, v115
    v_mfma_f32_16x16x32_bf16 v[100:103], a[144:147], a[80:83], v[100:103]
    ds_read_b64_tr_b16 a[240:241], v239 offset:33984
    v_cvt_pk_bf16_f32 v181, v114, v115
    v_mfma_f32_16x16x32_bf16 v[124:127], a[160:163], a[112:115], v[220:223]
    ds_read_b64_tr_b16 a[242:243], v239 offset:34240
    v_exp_f32 v136, v136
    v_mfma_f32_16x16x32_bf16 v[124:127], a[164:167], a[116:119], v[124:127]
    v_exp_f32 v137, v137
    v_mfma_f32_16x16x32_bf16 v[124:127], a[168:171], a[120:123], v[124:127]
    ds_read_b64_tr_b16 a[244:245], v239 offset:34496
    v_cvt_pk_bf16_f32 v198, v136, v137
    v_mfma_f32_16x16x32_bf16 v[124:127], a[172:175], a[124:127], v[124:127]
    ds_read_b64_tr_b16 a[246:247], v239 offset:34752
    v_exp_f32 v138, v138
    v_mfma_f32_16x16x32_bf16 v[116:119], a[172:175], a[92:95], v[212:215]
    ds_read_b64_tr_b16 a[248:249], v239 offset:34016
    v_exp_f32 v139, v139
    v_mfma_f32_16x16x32_bf16 v[116:119], a[168:171], a[88:91], v[116:119]
    v_exp_f32 v128, v128
    v_mfma_f32_16x16x32_bf16 v[116:119], a[164:167], a[84:87], v[116:119]
    ds_read_b64_tr_b16 a[250:251], v239 offset:34272
    v_cvt_pk_bf16_f32 v199, v138, v139
    v_mfma_f32_16x16x32_bf16 v[116:119], a[160:163], a[80:83], v[116:119]
    ds_read_b64_tr_b16 a[252:253], v239 offset:34528
    v_exp_f32 v129, v129
    v_mfma_f32_16x16x32_bf16 v[140:143], a[176:179], a[112:115], v[220:223]
    ds_read_b64_tr_b16 a[254:255], v239 offset:34784
    v_cvt_pk_bf16_f32 v182, v128, v129
    v_mfma_f32_16x16x32_bf16 v[140:143], a[180:183], a[116:119], v[140:143]
    s_waitcnt vmcnt(0) lgkmcnt(15)
    v_exp_f32 v130, v130
    v_mfma_f32_16x16x32_bf16 v[140:143], a[184:187], a[120:123], v[140:143]
    s_barrier
    v_mfma_f32_16x16x32_bf16 v[140:143], a[188:191], a[124:127], v[140:143]
    ds_read_b64_tr_b16 a[128:129], v239 offset:0
    v_mfma_f32_16x16x32_bf16 v[132:135], a[188:191], a[92:95], v[212:215]
    ds_read_b64_tr_b16 a[130:131], v239 offset:256
    v_mfma_f32_16x16x32_bf16 v[132:135], a[184:187], a[88:91], v[132:135]
    ds_read_b64_tr_b16 a[132:133], v239 offset:512
    v_mfma_f32_16x16x32_bf16 v[132:135], a[180:183], a[84:87], v[132:135]
    ds_read_b64_tr_b16 a[134:135], v239 offset:768
    v_mfma_f32_16x16x32_bf16 v[132:135], a[176:179], a[80:83], v[132:135]
    ds_read_b64_tr_b16 a[136:137], v239 offset:32
    v_smfmac_f32_16x16x64_bf16 v[228:231], v[224:227], v[144:151], v243
    ds_read_b64_tr_b16 a[138:139], v239 offset:288
    v_smfmac_f32_16x16x64_bf16 v[232:235], v[224:227], v[160:167], v243
    ds_read_b64_tr_b16 a[140:141], v239 offset:544
    v_smfmac_f32_16x16x64_bf16 v[228:231], v[252:255], v[152:159], v243
    s_waitcnt lgkmcnt(5)
    ds_read_b64_tr_b16 a[142:143], v239 offset:800
    v_smfmac_f32_16x16x64_bf16 v[232:235], v[252:255], v[168:175], v243
    ds_read_b64_tr_b16 a[144:145], v239 offset:64
    v_mfma_f32_16x16x32_bf16 a[0:3], v[160:163], a[192:195], a[0:3]
    ds_read_b64_tr_b16 a[146:147], v239 offset:320
    v_mfma_f32_16x16x32_bf16 a[0:3], v[164:167], a[196:199], a[0:3]
    ds_read_b64_tr_b16 a[148:149], v239 offset:576
    v_mfma_f32_16x16x32_bf16 a[8:11], v[164:167], a[204:207], a[8:11]
    ds_read_b64_tr_b16 a[150:151], v239 offset:832
    v_mfma_f32_16x16x32_bf16 a[8:11], v[160:163], a[200:203], a[8:11]
    ds_read_b64_tr_b16 a[152:153], v239 offset:96
    v_mfma_f32_16x16x32_bf16 v[16:19], v[144:147], a[192:195], v[16:19]
    ds_read_b64_tr_b16 a[154:155], v239 offset:352
    v_mfma_f32_16x16x32_bf16 v[16:19], v[148:151], a[196:199], v[16:19]
    ds_read_b64_tr_b16 a[156:157], v239 offset:608
    v_mfma_f32_16x16x32_bf16 v[20:23], v[148:151], a[204:207], v[20:23]
    ds_read_b64_tr_b16 a[158:159], v239 offset:864
    v_mfma_f32_16x16x32_bf16 v[20:23], v[144:147], a[200:203], v[20:23]
    ds_read_b64_tr_b16 a[160:161], v239 offset:128
    v_mfma_f32_16x16x32_bf16 a[16:19], v[160:163], a[208:211], a[16:19]
    ds_read_b64_tr_b16 a[162:163], v239 offset:384
    v_mfma_f32_16x16x32_bf16 a[16:19], v[164:167], a[212:215], a[16:19]
    ds_read_b64_tr_b16 a[164:165], v239 offset:640
    v_mfma_f32_16x16x32_bf16 a[24:27], v[164:167], a[220:223], a[24:27]
    ds_read_b64_tr_b16 a[166:167], v239 offset:896
    v_mfma_f32_16x16x32_bf16 a[24:27], v[160:163], a[216:219], a[24:27]
    ds_read_b64_tr_b16 a[168:169], v239 offset:160
    v_mfma_f32_16x16x32_bf16 a[32:35], v[160:163], a[224:227], a[32:35]
    ds_read_b64_tr_b16 a[170:171], v239 offset:416
    v_mfma_f32_16x16x32_bf16 a[32:35], v[164:167], a[228:231], a[32:35]
    ds_read_b64_tr_b16 a[172:173], v239 offset:672
    v_mfma_f32_16x16x32_bf16 a[40:43], v[164:167], a[236:239], a[40:43]
    ds_read_b64_tr_b16 a[174:175], v239 offset:928
    v_mfma_f32_16x16x32_bf16 a[40:43], v[160:163], a[232:235], a[40:43]
    ds_read_b64_tr_b16 a[176:177], v239 offset:192
    v_mfma_f32_16x16x32_bf16 a[48:51], v[160:163], a[240:243], a[48:51]
    ds_read_b64_tr_b16 a[178:179], v239 offset:448
    v_mfma_f32_16x16x32_bf16 a[48:51], v[164:167], a[244:247], a[48:51]
    ds_read_b64_tr_b16 a[180:181], v239 offset:704
    v_mfma_f32_16x16x32_bf16 a[56:59], v[164:167], a[252:255], a[56:59]
L_pad2:
    s_cbranch_execz L_x
    ds_read_b64_tr_b16 a[182:183], v239 offset:960
    v_mfma_f32_16x16x32_bf16 a[56:59], v[160:163], a[248:251], a[56:59]
    ds_read_b64_tr_b16 a[184:185], v239 offset:224
    v_smfmac_f32_16x16x64_bf16 v[232:235], v[224:227], v[192:199], v243
    s_waitcnt lgkmcnt(5)
    ds_read_b64_tr_b16 a[186:187], v239 offset:480
    v_mfma_f32_16x16x32_bf16 a[0:3], v[192:195], a[128:131], a[0:3]
    ds_read_b64_tr_b16 a[188:189], v239 offset:736
    v_mfma_f32_16x16x32_bf16 a[0:3], v[196:199], a[132:135], a[0:3]
    ds_read_b64_tr_b16 a[190:191], v239 offset:992
    v_mfma_f32_16x16x32_bf16 a[8:11], v[196:199], a[140:143], a[8:11]
    v_exp_f32 v131, v131
    v_mfma_f32_16x16x32_bf16 a[8:11], v[192:195], a[136:139], a[8:11]
    v_add_f32 v236, v232, v233
    v_cvt_pk_bf16_f32 v183, v130, v131
    v_mfma_f32_16x16x32_bf16 a[16:19], v[192:195], a[144:147], a[16:19]
    v_exp_f32 v92, v92
    v_mfma_f32_16x16x32_bf16 a[16:19], v[196:199], a[148:151], a[16:19]
    v_exp_f32 v93, v93
    v_mfma_f32_16x16x32_bf16 a[24:27], v[196:199], a[156:159], a[24:27]
    ds_write_b128 v8, a[0:3] offset:0
    v_mfma_f32_16x16x32_bf16 a[24:27], v[192:195], a[152:155], a[24:27]
    v_exp_f32 v94, v94
    v_mfma_f32_16x16x32_bf16 a[32:35], v[192:195], a[160:163], a[32:35]
    ds_write_b128 v8, a[8:11] offset:1024
    v_mfma_f32_16x16x32_bf16 a[32:35], v[196:199], a[164:167], a[32:35]
    v_exp_f32 v95, v95
    v_mfma_f32_16x16x32_bf16 a[40:43], v[196:199], a[172:175], a[40:43]
    s_waitcnt lgkmcnt(2)
    v_exp_f32 v108, v108
    v_mfma_f32_16x16x32_bf16 a[40:43], v[192:195], a[168:171], a[40:43]
    ds_write_b128 v8, a[16:19] offset:2048
    v_mfma_f32_16x16x32_bf16 a[48:51], v[192:195], a[176:179], a[48:51]
    v_exp_f32 v109, v109
    v_mfma_f32_16x16x32_bf16 a[48:51], v[196:199], a[180:183], a[48:51]
    v_exp_f32 v110, v110
    v_mfma_f32_16x16x32_bf16 a[56:59], v[196:199], a[188:191], a[56:59]
    ds_write_b128 v8, a[24:27] offset:3072
    v_mfma_f32_16x16x32_bf16 a[56:59], v[192:195], a[184:187], a[56:59]
    v_exp_f32 v111, v111
    v_mfma_f32_16x16x32_bf16 v[24:27], v[144:147], a[208:211], v[24:27]
    v_exp_f32 v124, v124
    v_mfma_f32_16x16x32_bf16 v[24:27], v[148:151], a[212:215], v[24:27]
    ds_write_b128 v8, a[32:35] offset:4096
    v_mfma_f32_16x16x32_bf16 v[28:31], v[148:151], a[220:223], v[28:31]
    v_exp_f32 v125, v125
    v_mfma_f32_16x16x32_bf16 v[28:31], v[144:147], a[216:219], v[28:31]
    v_exp_f32 v126, v126
    v_mfma_f32_16x16x32_bf16 v[32:35], v[144:147], a[224:227], v[32:35]
    ds_write_b32 v10, v236 offset:256
    v_mfma_f32_16x16x32_bf16 v[32:35], v[148:151], a[228:231], v[32:35]
    v_exp_f32 v127, v127
    v_mfma_f32_16x16x32_bf16 v[36:39], v[148:151], a[236:239], v[36:39]
    ds_write_b128 v8, a[40:43] offset:5120
    v_mfma_f32_16x16x32_bf16 v[36:39], v[144:147], a[232:235], v[36:39]
    v_exp_f32 v140, v140
    v_mfma_f32_16x16x32_bf16 v[40:43], v[144:147], a[240:243], v[40:43]
    v_exp_f32 v141, v141
    v_mfma_f32_16x16x32_bf16 v[40:43], v[148:151], a[244:247], v[40:43]
    ds_write_b128 v8, a[48:51] offset:6144
    v_mfma_f32_16x16x32_bf16 v[44:47], v[148:151], a[252:255], v[44:47]
    v_exp_f32 v142, v142
    v_mfma_f32_16x16x32_bf16 v[44:47], v[144:147], a[248:251], v[44:47]
    v_exp_f32 v143, v143
    v_smfmac_f32_16x16x64_bf16 v[228:231], v[224:227], v[176:183], v243
    v_cvt_pk_bf16_f32 v200, v92, v93
    v_mfma_f32_16x16x32_bf16 v[16:19], v[176:179], a[128:131], v[16:19]
    ds_write_b128 v8, a[56:59] offset:7168
    v_mfma_f32_16x16x32_bf16 v[16:19], v[180:183], a[132:135], v[16:19]
    v_exp_f32 v84, v84
    v_mfma_f32_16x16x32_bf16 v[20:23], v[180:183], a[140:143], v[20:23]
    v_exp_f32 v85, v85
    v_mfma_f32_16x16x32_bf16 v[20:23], v[176:179], a[136:139], v[20:23]
    v_add_f32 v249, v228, v229
    v_cvt_pk_bf16_f32 v201, v94, v95
    v_mfma_f32_16x16x32_bf16 v[24:27], v[176:179], a[144:147], v[24:27]
    s_waitcnt lgkmcnt(0)
    v_exp_f32 v86, v86
    v_mfma_f32_16x16x32_bf16 v[24:27], v[180:183], a[148:151], v[24:27]
    s_barrier
    v_mfma_f32_16x16x32_bf16 v[28:31], v[180:183], a[156:159], v[28:31]
    ds_read_b128 v[0:3], v248 offset:256
    v_cvt_pk_bf16_f32 v202, v108, v109
    v_mfma_f32_16x16x32_bf16 v[28:31], v[176:179], a[152:155], v[28:31]
    ds_read_b128 v[88:91], v9 offset:0
    v_cvt_pk_bf16_f32 v203, v110, v111
    v_mfma_f32_16x16x32_bf16 a[4:7], v[168:171], a[192:195], a[4:7]
    ds_read_b128 v[104:107], v9 offset:1024
    v_cvt_pk_bf16_f32 v204, v124, v125
    v_mfma_f32_16x16x32_bf16 a[4:7], v[172:175], a[196:199], a[4:7]
    ds_write_b32 v246, v249 offset:0
    v_mfma_f32_16x16x32_bf16 a[12:15], v[172:175], a[204:207], a[12:15]
    ds_read_b128 v[120:123], v9 offset:2048
    v_cvt_pk_bf16_f32 v205, v126, v127
    v_mfma_f32_16x16x32_bf16 a[12:15], v[168:171], a[200:203], a[12:15]
    ds_read_b128 v[4:7], v248 offset:0
    v_cvt_pk_bf16_f32 v206, v140, v141
    v_mfma_f32_16x16x32_bf16 a[20:23], v[168:171], a[208:211], a[20:23]
    ds_read_b128 v[136:139], v9 offset:3072
    v_cvt_pk_bf16_f32 v207, v142, v143
    v_mfma_f32_16x16x32_bf16 a[20:23], v[172:175], a[212:215], a[20:23]
    ds_read_b128 v[80:83], v9 offset:4096
    v_cvt_pk_bf16_f32 v184, v84, v85
    v_mfma_f32_16x16x32_bf16 a[28:31], v[172:175], a[220:223], a[28:31]
    ds_read_b128 v[96:99], v9 offset:5120
    v_mfma_f32_16x16x32_bf16 a[28:31], v[168:171], a[216:219], a[28:31]
    ds_read_b128 v[112:115], v9 offset:6144
    v_mfma_f32_16x16x32_bf16 a[36:39], v[168:171], a[224:227], a[36:39]
    ds_read_b128 v[128:131], v9 offset:7168
    v_mfma_f32_16x16x32_bf16 a[36:39], v[172:175], a[228:231], a[36:39]
    v_exp_f32 v87, v87
    v_mfma_f32_16x16x32_bf16 a[44:47], v[172:175], a[236:239], a[44:47]
    s_waitcnt lgkmcnt(5)
    v_add_f32 v208, v0, v4
    v_add_f32 v209, v1, v5
    v_mfma_f32_16x16x32_bf16 a[44:47], v[168:171], a[232:235], a[44:47]
    v_add_f32 v210, v2, v6
    v_add_f32 v211, v3, v7
    v_mfma_f32_16x16x32_bf16 a[52:55], v[168:171], a[240:243], a[52:55]
    v_rcp_f32 v208, v208
    v_mfma_f32_16x16x32_bf16 a[52:55], v[172:175], a[244:247], a[52:55]
    v_rcp_f32 v209, v209
    v_mfma_f32_16x16x32_bf16 a[60:63], v[172:175], a[252:255], a[60:63]
    v_rcp_f32 v210, v210
    v_mfma_f32_16x16x32_bf16 a[60:63], v[168:171], a[248:251], a[60:63]
    v_rcp_f32 v211, v211
    v_cvt_pk_bf16_f32 v185, v86, v87
    v_exp_f32 v100, v100
    v_pk_add_f32 v[16:17], v[88:89], v[16:17]
    v_pk_add_f32 v[18:19], v[90:91], v[18:19]
    v_pk_add_f32 v[20:21], v[104:105], v[20:21]
    v_pk_add_f32 v[22:23], v[106:107], v[22:23]
    v_pk_add_f32 v[24:25], v[120:121], v[24:25]
    v_pk_add_f32 v[26:27], v[122:123], v[26:27]
    s_waitcnt lgkmcnt(0)
    v_pk_add_f32 v[28:29], v[136:137], v[28:29]
    v_pk_add_f32 v[30:31], v[138:139], v[30:31]
    v_pk_mul_f32 v[16:17], v[16:17], v[208:209]
    v_pk_mul_f32 v[20:21], v[20:21], v[208:209]
    v_pk_mul_f32 v[24:25], v[24:25], v[208:209]
    v_pk_mul_f32 v[28:29], v[28:29], v[208:209]
    v_pk_mul_f32 v[18:19], v[18:19], v[210:211]
    v_pk_mul_f32 v[22:23], v[22:23], v[210:211]
    v_pk_mul_f32 v[26:27], v[26:27], v[210:211]
    v_pk_mul_f32 v[30:31], v[30:31], v[210:211]
    v_pk_add_f32 v[32:33], v[80:81], v[32:33]
    v_pk_add_f32 v[34:35], v[82:83], v[34:35]
    v_pk_add_f32 v[36:37], v[96:97], v[36:37]
    v_pk_add_f32 v[38:39], v[98:99], v[38:39]
    v_pk_add_f32 v[40:41], v[112:113], v[40:41]
    v_pk_add_f32 v[42:43], v[114:115], v[42:43]
    v_pk_add_f32 v[44:45], v[128:129], v[44:45]
    v_pk_add_f32 v[46:47], v[130:131], v[46:47]
    v_mfma_f32_16x16x32_bf16 v[32:35], v[176:179], a[160:163], v[32:35]
    v_cvt_pk_bf16_f32 v88, v16, v20
    v_cvt_pk_bf16_f32 v89, v24, v28
    v_mfma_f32_16x16x32_bf16 v[32:35], v[180:183], a[164:167], v[32:35]
    ds_write_b64 v245, v[88:89] offset:0
    v_mfma_f32_16x16x32_bf16 v[36:39], v[180:183], a[172:175], v[36:39]
    v_cvt_pk_bf16_f32 v104, v17, v21
    v_cvt_pk_bf16_f32 v105, v25, v29
    v_mfma_f32_16x16x32_bf16 v[36:39], v[176:179], a[168:171], v[36:39]
    ds_write_b64 v245, v[104:105] offset:128
    v_mfma_f32_16x16x32_bf16 v[40:43], v[176:179], a[176:179], v[40:43]
    v_cvt_pk_bf16_f32 v90, v18, v22
    v_cvt_pk_bf16_f32 v91, v26, v30
    v_mfma_f32_16x16x32_bf16 v[40:43], v[180:183], a[180:183], v[40:43]
    ds_write_b64 v245, v[90:91] offset:288
    v_mfma_f32_16x16x32_bf16 v[44:47], v[180:183], a[188:191], v[44:47]
    v_cvt_pk_bf16_f32 v106, v19, v23
    v_cvt_pk_bf16_f32 v107, v27, v31
    v_mfma_f32_16x16x32_bf16 v[44:47], v[176:179], a[184:187], v[44:47]
    ds_write_b64 v245, v[106:107] offset:416
    v_smfmac_f32_16x16x64_bf16 v[232:235], v[252:255], v[200:207], v243
    ds_read_b64_tr_b16 v[16:17], v250 offset:0
    ds_read_b64_tr_b16 v[18:19], v250 offset:32
    ds_read_b64_tr_b16 v[20:21], v250 offset:1152
    ds_read_b64_tr_b16 v[22:23], v250 offset:1184
    v_pk_mul_f32 v[32:33], v[32:33], v[208:209]
    v_pk_mul_f32 v[36:37], v[36:37], v[208:209]
    v_pk_mul_f32 v[40:41], v[40:41], v[208:209]
    v_pk_mul_f32 v[44:45], v[44:45], v[208:209]
    v_pk_mul_f32 v[34:35], v[34:35], v[210:211]
    v_pk_mul_f32 v[38:39], v[38:39], v[210:211]
    v_pk_mul_f32 v[42:43], v[42:43], v[210:211]
    v_pk_mul_f32 v[46:47], v[46:47], v[210:211]
    v_mfma_f32_16x16x32_bf16 a[4:7], v[200:203], a[128:131], a[4:7]
    v_add_f32 v237, v234, v235
    v_cvt_pk_bf16_f32 v80, v32, v36
    v_mfma_f32_16x16x32_bf16 a[4:7], v[204:207], a[132:135], a[4:7]
    v_cvt_pk_bf16_f32 v81, v40, v44
    v_cvt_pk_bf16_f32 v96, v33, v37
    v_mfma_f32_16x16x32_bf16 a[12:15], v[204:207], a[140:143], a[12:15]
    ds_write_b64 v245, v[80:81] offset:4096
    v_mfma_f32_16x16x32_bf16 a[12:15], v[200:203], a[136:139], a[12:15]
    v_cvt_pk_bf16_f32 v97, v41, v45
    v_cvt_pk_bf16_f32 v82, v34, v38
    v_mfma_f32_16x16x32_bf16 a[20:23], v[200:203], a[144:147], a[20:23]
    ds_write_b128 v8, a[4:7] offset:8192
    v_mfma_f32_16x16x32_bf16 a[20:23], v[204:207], a[148:151], a[20:23]
    v_cvt_pk_bf16_f32 v83, v42, v46
    v_cvt_pk_bf16_f32 v98, v35, v39
    v_mfma_f32_16x16x32_bf16 a[28:31], v[204:207], a[156:159], a[28:31]
    v_cvt_pk_bf16_f32 v99, v43, v47
    v_mfma_f32_16x16x32_bf16 a[28:31], v[200:203], a[152:155], a[28:31]
    ds_write_b64 v245, v[96:97] offset:4224
    v_mfma_f32_16x16x32_bf16 a[36:39], v[200:203], a[160:163], a[36:39]
    v_exp_f32 v101, v101
    v_mfma_f32_16x16x32_bf16 a[36:39], v[204:207], a[164:167], a[36:39]
    ds_write_b128 v8, a[12:15] offset:9216
    v_mfma_f32_16x16x32_bf16 a[44:47], v[204:207], a[172:175], a[44:47]
    s_waitcnt lgkmcnt(4)
    global_store_dwordx4 v247, v[16:19], s[50:51] offset:-4096 sc0 sc1
    v_cvt_pk_bf16_f32 v186, v100, v101
    v_exp_f32 v102, v102
    v_mfma_f32_16x16x32_bf16 a[44:47], v[200:203], a[168:171], a[44:47]
    ds_write_b64 v245, v[82:83] offset:4384
    v_mfma_f32_16x16x32_bf16 a[52:55], v[200:203], a[176:179], a[52:55]
    v_exp_f32 v103, v103
    v_mfma_f32_16x16x32_bf16 a[52:55], v[204:207], a[180:183], a[52:55]
    ds_write_b128 v8, a[20:23] offset:10240
    v_mfma_f32_16x16x32_bf16 a[60:63], v[204:207], a[188:191], a[60:63]
    global_store_dwordx4 v247, v[20:23], s[50:51] offset:-2048 sc0 sc1
    v_cvt_pk_bf16_f32 v187, v102, v103
    v_exp_f32 v116, v116
    v_mfma_f32_16x16x32_bf16 a[60:63], v[200:203], a[184:187], a[60:63]
    ds_write_b128 v8, a[28:31] offset:11264
    v_mfma_f32_16x16x32_bf16 v[48:51], v[152:155], a[192:195], v[48:51]
    v_exp_f32 v117, v117
    v_mfma_f32_16x16x32_bf16 v[48:51], v[156:159], a[196:199], v[48:51]
    v_exp_f32 v118, v118
    v_mfma_f32_16x16x32_bf16 v[52:55], v[156:159], a[204:207], v[52:55]
    ds_write_b64 v245, v[98:99] offset:4512
    v_mfma_f32_16x16x32_bf16 v[52:55], v[152:155], a[200:203], v[52:55]
    v_exp_f32 v119, v119
    v_mfma_f32_16x16x32_bf16 v[56:59], v[152:155], a[208:211], v[56:59]
    ds_write_b128 v8, a[36:39] offset:12288
    v_mfma_f32_16x16x32_bf16 v[56:59], v[156:159], a[212:215], v[56:59]
    v_exp_f32 v132, v132
    v_mfma_f32_16x16x32_bf16 v[60:63], v[156:159], a[220:223], v[60:63]
    v_cvt_pk_bf16_f32 v188, v116, v117
    v_cvt_pk_bf16_f32 v189, v118, v119
    v_mfma_f32_16x16x32_bf16 v[60:63], v[152:155], a[216:219], v[60:63]
    ds_write_b32 v10, v237 offset:320
    ds_read_b64_tr_b16 v[32:33], v250 offset:4096
    v_exp_f32 v133, v133
    ds_write_b128 v8, a[44:47] offset:13312
    v_cvt_pk_bf16_f32 v190, v132, v133
    ds_read_b64_tr_b16 v[34:35], v250 offset:4128
    ds_read_b64_tr_b16 v[36:37], v250 offset:5248
    ds_write_b128 v8, a[52:55] offset:14336
    v_exp_f32 v134, v134
    ds_read_b64_tr_b16 v[38:39], v250 offset:5280
    v_exp_f32 v135, v135
    ds_write_b128 v8, a[60:63] offset:15360
    v_cvt_pk_bf16_f32 v191, v134, v135
    s_nop 1
    v_smfmac_f32_16x16x64_bf16 v[228:231], v[252:255], v[184:191], v243
    v_mfma_f32_16x16x32_bf16 v[48:51], v[184:187], a[128:131], v[48:51]
    v_mfma_f32_16x16x32_bf16 v[48:51], v[188:191], a[132:135], v[48:51]
    s_waitcnt lgkmcnt(0)
    v_mfma_f32_16x16x32_bf16 v[52:55], v[188:191], a[140:143], v[52:55]
    s_barrier
    v_mfma_f32_16x16x32_bf16 v[52:55], v[184:187], a[136:139], v[52:55]
    ds_read_b128 v[12:15], v248 offset:320
    v_mfma_f32_16x16x32_bf16 v[56:59], v[184:187], a[144:147], v[56:59]
    ds_read_b128 v[92:95], v9 offset:8192
    v_add_f32 v11, v230, v231
    v_mfma_f32_16x16x32_bf16 v[56:59], v[188:191], a[148:151], v[56:59]
    s_waitcnt lgkmcnt(3)
    global_store_dwordx4 v247, v[32:35], s[50:51] offset:-3968 sc0 sc1
    v_mfma_f32_16x16x32_bf16 v[60:63], v[188:191], a[156:159], v[60:63]
    ds_write_b32 v246, v11 offset:64
    v_mfma_f32_16x16x32_bf16 v[60:63], v[184:187], a[152:155], v[60:63]
    ds_read_b128 v[108:111], v9 offset:9216
    ds_read_b128 v[216:219], v248 offset:64
    ds_read_b128 v[124:127], v9 offset:10240
    global_store_dwordx4 v247, v[36:39], s[50:51] offset:-1920 sc0 sc1
    ds_read_b128 v[140:143], v9 offset:11264
    ds_read_b128 v[160:163], v9 offset:12288
    ds_read_b128 v[192:195], v9 offset:13312
    ds_read_b128 v[164:167], v9 offset:14336
    s_waitcnt lgkmcnt(8)
    v_pk_add_f32 v[48:49], v[92:93], v[48:49]
    v_pk_add_f32 v[50:51], v[94:95], v[50:51]
    s_waitcnt lgkmcnt(6)
    v_pk_add_f32 v[52:53], v[108:109], v[52:53]
    v_pk_add_f32 v[54:55], v[110:111], v[54:55]
    s_waitcnt lgkmcnt(5)
    v_add_f32 v212, v12, v216
    v_add_f32 v213, v13, v217
    v_add_f32 v214, v14, v218
    s_waitcnt lgkmcnt(4)
    v_pk_add_f32 v[56:57], v[124:125], v[56:57]
    v_pk_add_f32 v[58:59], v[126:127], v[58:59]
    v_add_f32 v215, v15, v219
    s_waitcnt lgkmcnt(3)
    v_pk_add_f32 v[60:61], v[140:141], v[60:61]
    v_pk_add_f32 v[62:63], v[142:143], v[62:63]
    v_rcp_f32 v212, v212
    v_rcp_f32 v213, v213
    v_rcp_f32 v214, v214
    v_pk_mul_f32 v[48:49], v[48:49], v[212:213]
    v_pk_mul_f32 v[52:53], v[52:53], v[212:213]
    v_pk_mul_f32 v[56:57], v[56:57], v[212:213]
    v_pk_mul_f32 v[60:61], v[60:61], v[212:213]
    v_rcp_f32 v215, v215
    v_cvt_pk_bf16_f32 v92, v48, v52
    v_pk_mul_f32 v[50:51], v[50:51], v[214:215]
    v_pk_mul_f32 v[54:55], v[54:55], v[214:215]
    v_pk_mul_f32 v[58:59], v[58:59], v[214:215]
    v_pk_mul_f32 v[62:63], v[62:63], v[214:215]
    v_mfma_f32_16x16x32_bf16 v[64:67], v[152:155], a[224:227], v[64:67]
    ds_read_b128 v[196:199], v9 offset:15360
    v_cvt_pk_bf16_f32 v93, v56, v60
    v_mfma_f32_16x16x32_bf16 v[64:67], v[156:159], a[228:231], v[64:67]
    ds_write_b64 v245, v[92:93] offset:8192
    v_mfma_f32_16x16x32_bf16 v[68:71], v[156:159], a[236:239], v[68:71]
    v_cvt_pk_bf16_f32 v108, v49, v53
    v_cvt_pk_bf16_f32 v109, v57, v61
    v_mfma_f32_16x16x32_bf16 v[68:71], v[152:155], a[232:235], v[68:71]
    ds_write_b64 v245, v[108:109] offset:8320
    v_mfma_f32_16x16x32_bf16 v[72:75], v[152:155], a[240:243], v[72:75]
    v_cvt_pk_bf16_f32 v94, v50, v54
    v_cvt_pk_bf16_f32 v95, v58, v62
    v_mfma_f32_16x16x32_bf16 v[72:75], v[156:159], a[244:247], v[72:75]
    ds_write_b64 v245, v[94:95] offset:8480
    v_mfma_f32_16x16x32_bf16 v[76:79], v[156:159], a[252:255], v[76:79]
    v_cvt_pk_bf16_f32 v110, v51, v55
    v_cvt_pk_bf16_f32 v111, v59, v63
    v_mfma_f32_16x16x32_bf16 v[76:79], v[152:155], a[248:251], v[76:79]
    ds_write_b64 v245, v[110:111] offset:8608
    ds_read_b64_tr_b16 v[48:49], v250 offset:8192
    s_waitcnt lgkmcnt(5)
    v_pk_add_f32 v[64:65], v[160:161], v[64:65]
    v_pk_add_f32 v[66:67], v[162:163], v[66:67]
    v_pk_add_f32 v[68:69], v[192:193], v[68:69]
    v_pk_add_f32 v[70:71], v[194:195], v[70:71]
    v_pk_add_f32 v[72:73], v[164:165], v[72:73]
    v_pk_add_f32 v[74:75], v[166:167], v[74:75]
    v_pk_add_f32 v[76:77], v[196:197], v[76:77]
    v_pk_add_f32 v[78:79], v[198:199], v[78:79]
    v_mfma_f32_16x16x32_bf16 v[64:67], v[184:187], a[160:163], v[64:67]
    ds_read_b64_tr_b16 v[50:51], v250 offset:8224
    v_mfma_f32_16x16x32_bf16 v[64:67], v[188:191], a[164:167], v[64:67]
    ds_read_b64_tr_b16 v[52:53], v250 offset:9344
    v_mfma_f32_16x16x32_bf16 v[68:71], v[188:191], a[172:175], v[68:71]
    ds_read_b64_tr_b16 v[54:55], v250 offset:9376
    v_mfma_f32_16x16x32_bf16 v[68:71], v[184:187], a[168:171], v[68:71]
    v_mfma_f32_16x16x32_bf16 v[72:75], v[184:187], a[176:179], v[72:75]
    v_mfma_f32_16x16x32_bf16 v[72:75], v[188:191], a[180:183], v[72:75]
    v_mfma_f32_16x16x32_bf16 v[76:79], v[188:191], a[188:191], v[76:79]
    v_mfma_f32_16x16x32_bf16 v[76:79], v[184:187], a[184:187], v[76:79]
    s_waitcnt lgkmcnt(2)
    global_store_dwordx4 v247, v[48:51], s[50:51] offset:0 sc0 sc1
    v_pk_mul_f32 v[64:65], v[64:65], v[212:213]
    v_pk_mul_f32 v[66:67], v[66:67], v[214:215]
    v_pk_mul_f32 v[68:69], v[68:69], v[212:213]
    v_pk_mul_f32 v[70:71], v[70:71], v[214:215]
    v_pk_mul_f32 v[72:73], v[72:73], v[212:213]
    v_pk_mul_f32 v[74:75], v[74:75], v[214:215]
    v_pk_mul_f32 v[76:77], v[76:77], v[212:213]
    v_pk_mul_f32 v[78:79], v[78:79], v[214:215]
    v_cvt_pk_bf16_f32 v160, v64, v68
    v_cvt_pk_bf16_f32 v161, v72, v76
    ds_write_b64 v245, v[160:161] offset:12288
    v_cvt_pk_bf16_f32 v192, v65, v69
    v_cvt_pk_bf16_f32 v193, v73, v77
    ds_write_b64 v245, v[192:193] offset:12416
    s_waitcnt lgkmcnt(2)
    global_store_dwordx4 v247, v[52:55], s[50:51] offset:2048 sc0 sc1
    v_cvt_pk_bf16_f32 v162, v66, v70
    v_cvt_pk_bf16_f32 v163, v74, v78
    ds_write_b64 v245, v[162:163] offset:12576
    v_cvt_pk_bf16_f32 v194, v67, v71
    v_cvt_pk_bf16_f32 v195, v75, v79
    ds_write_b64 v245, v[194:195] offset:12704
    ds_read_b64_tr_b16 v[64:65], v250 offset:12288
    ds_read_b64_tr_b16 v[66:67], v250 offset:12320
    ds_read_b64_tr_b16 v[68:69], v250 offset:13440
    ds_read_b64_tr_b16 v[70:71], v250 offset:13472
    v_max3_u32 v0, v208, v209, v210
    v_max3_u32 v0, v0, v211, v212
    s_waitcnt lgkmcnt(2)
    global_store_dwordx4 v247, v[64:67], s[50:51] offset:128 sc0 sc1
    v_max3_u32 v0, v0, v213, v214
    v_max_u32 v0, v0, v215
    v_min3_u32 v1, v208, v209, v210
    v_min3_u32 v1, v1, v211, v212
    v_min3_u32 v1, v1, v213, v214
    v_min_u32 v1, v1, v215
    v_cmp_lt_u32 s[40:41], s30, v0
    v_cmp_gt_u32 vcc, s47, v1
    s_waitcnt lgkmcnt(0)
    global_store_dwordx4 v247, v[68:71], s[50:51] offset:2176 sc0 sc1
    v_mov_b32 v4, 135168
    s_nop 2
    s_or_b64 s[40:41], s[40:41], vcc
    s_cselect_b32 s31, 1, 0
    v_mov_b32 v0, s31
    ds_write_b32 v251, v0
    s_waitcnt lgkmcnt(0)
    s_barrier
    ds_read_b128 v[0:3], v4
    s_waitcnt lgkmcnt(0)
    v_or_b32 v0, v0, v1
    v_or3_b32 v0, v0, v2, v3
    s_nop 0
    v_readfirstlane_b32 s31, v0
    s_nop 3
    s_andn2_b32 s31, s31, s27
    s_cbranch_scc1 L_fallback
L_end:
    s_endpgm
L_fallback:
    s_mov_b32 s27, 1
    s_mov_b64 s[16:17], s[20:21]
    s_mov_b32 s25, 0
    s_waitcnt vmcnt(0) lgkmcnt(0)
    v_mov_b32 v252, 0xff800000
    v_mov_b32 v253, 0xff800000
    v_mov_b32 v254, 0xff800000
    v_mov_b32 v255, 0xff800000
L_fbloop:
    s_barrier
    s_add_u32 m0, s24, 4096
    s_nop 0
    global_load_lds_dwordx4 v241, s[16:17] offset:-4096 nt
    s_add_u32 m0, s24, 4128
    s_nop 0
    global_load_lds_dwordx4 v241, s[16:17] offset:-3072 nt
    s_add_u32 m0, s24, 4160
    s_nop 0
    global_load_lds_dwordx4 v241, s[16:17] offset:-2048 nt
    s_add_u32 m0, s24, 4192
    s_nop 0
    global_load_lds_dwordx4 v241, s[16:17] offset:-1024 nt
    s_add_u32 m0, s24, 4224
    s_nop 0
    global_load_lds_dwordx4 v241, s[16:17] offset:0 nt
    s_add_u32 m0, s24, 4256
    s_nop 0
    global_load_lds_dwordx4 v241, s[16:17] offset:1024 nt
    s_add_u32 m0, s24, 4288
    s_nop 0
    global_load_lds_dwordx4 v241, s[16:17] offset:2048 nt
    s_add_u32 m0, s24, 4320
    s_nop 0
    global_load_lds_dwordx4 v241, s[16:17] offset:3072 nt
    s_add_u32 s16, s16, s26
    s_addc_u32 s17, s17, 0
    s_waitcnt vmcnt(0)
    s_barrier
    ds_read_b128 a[128:131], v238 offset:0
    ds_read_b128 a[132:135], v238 offset:64
    ds_read_b128 a[136:139], v238 offset:128
    ds_read_b128 a[140:143], v238 offset:192
    ds_read_b128 a[144:147], v238 offset:256
    ds_read_b128 a[148:151], v238 offset:320
    ds_read_b128 a[152:155], v238 offset:384
    ds_read_b128 a[156:159], v238 offset:448
    ds_read_b128 a[160:163], v238 offset:512
    ds_read_b128 a[164:167], v238 offset:576
    ds_read_b128 a[168:171], v238 offset:640
    ds_read_b128 a[172:175], v238 offset:704
    ds_read_b128 a[176:179], v238 offset:768
    ds_read_b128 a[180:183], v238 offset:832
    ds_read_b128 a[184:187], v238 offset:896
    ds_read_b128 a[188:191], v238 offset:960
    s_waitcnt lgkmcnt(0)
    v_mfma_f32_16x16x32_bf16 v[80:83], a[128:131], a[64:67], 0
    v_mfma_f32_16x16x32_bf16 v[80:83], a[132:135], a[68:71], v[80:83]
    v_mfma_f32_16x16x32_bf16 v[80:83], a[136:139], a[72:75], v[80:83]
    v_mfma_f32_16x16x32_bf16 v[80:83], a[140:143], a[76:79], v[80:83]
    v_mfma_f32_16x16x32_bf16 v[84:87], a[128:131], a[80:83], 0
    v_mfma_f32_16x16x32_bf16 v[84:87], a[132:135], a[84:87], v[84:87]
    v_mfma_f32_16x16x32_bf16 v[84:87], a[136:139], a[88:91], v[84:87]
    v_mfma_f32_16x16x32_bf16 v[84:87], a[140:143], a[92:95], v[84:87]
    v_mfma_f32_16x16x32_bf16 v[88:91], a[128:131], a[96:99], 0
    v_mfma_f32_16x16x32_bf16 v[88:91], a[132:135], a[100:103], v[88:91]
    v_mfma_f32_16x16x32_bf16 v[88:91], a[136:139], a[104:107], v[88:91]
    v_mfma_f32_16x16x32_bf16 v[88:91], a[140:143], a[108:111], v[88:91]
    v_mfma_f32_16x16x32_bf16 v[92:95], a[128:131], a[112:115], 0
    v_mfma_f32_16x16x32_bf16 v[92:95], a[132:135], a[116:119], v[92:95]
    v_mfma_f32_16x16x32_bf16 v[92:95], a[136:139], a[120:123], v[92:95]
    v_mfma_f32_16x16x32_bf16 v[92:95], a[140:143], a[124:127], v[92:95]
    v_mfma_f32_16x16x32_bf16 v[96:99], a[144:147], a[64:67], 0
    v_mfma_f32_16x16x32_bf16 v[96:99], a[148:151], a[68:71], v[96:99]
    v_mfma_f32_16x16x32_bf16 v[96:99], a[152:155], a[72:75], v[96:99]
    v_mfma_f32_16x16x32_bf16 v[96:99], a[156:159], a[76:79], v[96:99]
    v_mfma_f32_16x16x32_bf16 v[100:103], a[144:147], a[80:83], 0
    v_mfma_f32_16x16x32_bf16 v[100:103], a[148:151], a[84:87], v[100:103]
    v_mfma_f32_16x16x32_bf16 v[100:103], a[152:155], a[88:91], v[100:103]
    v_mfma_f32_16x16x32_bf16 v[100:103], a[156:159], a[92:95], v[100:103]
    v_mfma_f32_16x16x32_bf16 v[104:107], a[144:147], a[96:99], 0
    v_mfma_f32_16x16x32_bf16 v[104:107], a[148:151], a[100:103], v[104:107]
    v_mfma_f32_16x16x32_bf16 v[104:107], a[152:155], a[104:107], v[104:107]
    v_mfma_f32_16x16x32_bf16 v[104:107], a[156:159], a[108:111], v[104:107]
    v_mfma_f32_16x16x32_bf16 v[108:111], a[144:147], a[112:115], 0
    v_mfma_f32_16x16x32_bf16 v[108:111], a[148:151], a[116:119], v[108:111]
    v_mfma_f32_16x16x32_bf16 v[108:111], a[152:155], a[120:123], v[108:111]
    v_mfma_f32_16x16x32_bf16 v[108:111], a[156:159], a[124:127], v[108:111]
    v_mfma_f32_16x16x32_bf16 v[112:115], a[160:163], a[64:67], 0
    v_mfma_f32_16x16x32_bf16 v[112:115], a[164:167], a[68:71], v[112:115]
    v_mfma_f32_16x16x32_bf16 v[112:115], a[168:171], a[72:75], v[112:115]
    v_mfma_f32_16x16x32_bf16 v[112:115], a[172:175], a[76:79], v[112:115]
    v_mfma_f32_16x16x32_bf16 v[116:119], a[160:163], a[80:83], 0
    v_mfma_f32_16x16x32_bf16 v[116:119], a[164:167], a[84:87], v[116:119]
    v_mfma_f32_16x16x32_bf16 v[116:119], a[168:171], a[88:91], v[116:119]
    v_mfma_f32_16x16x32_bf16 v[116:119], a[172:175], a[92:95], v[116:119]
    v_mfma_f32_16x16x32_bf16 v[120:123], a[160:163], a[96:99], 0
    v_mfma_f32_16x16x32_bf16 v[120:123], a[164:167], a[100:103], v[120:123]
    v_mfma_f32_16x16x32_bf16 v[120:123], a[168:171], a[104:107], v[120:123]
    v_mfma_f32_16x16x32_bf16 v[120:123], a[172:175], a[108:111], v[120:123]
    v_mfma_f32_16x16x32_bf16 v[124:127], a[160:163], a[112:115], 0
    v_mfma_f32_16x16x32_bf16 v[124:127], a[164:167], a[116:119], v[124:127]
    v_mfma_f32_16x16x32_bf16 v[124:127], a[168:171], a[120:123], v[124:127]
    v_mfma_f32_16x16x32_bf16 v[124:127], a[172:175], a[124:127], v[124:127]
    v_mfma_f32_16x16x32_bf16 v[128:131], a[176:179], a[64:67], 0
    v_mfma_f32_16x16x32_bf16 v[128:131], a[180:183], a[68:71], v[128:131]
    v_mfma_f32_16x16x32_bf16 v[128:131], a[184:187], a[72:75], v[128:131]
    v_mfma_f32_16x16x32_bf16 v[128:131], a[188:191], a[76:79], v[128:131]
    v_mfma_f32_16x16x32_bf16 v[132:135], a[176:179], a[80:83], 0
    v_mfma_f32_16x16x32_bf16 v[132:135], a[180:183], a[84:87], v[132:135]
    v_mfma_f32_16x16x32_bf16 v[132:135], a[184:187], a[88:91], v[132:135]
    v_mfma_f32_16x16x32_bf16 v[132:135], a[188:191], a[92:95], v[132:135]
    v_mfma_f32_16x16x32_bf16 v[136:139], a[176:179], a[96:99], 0
    v_mfma_f32_16x16x32_bf16 v[136:139], a[180:183], a[100:103], v[136:139]
    v_mfma_f32_16x16x32_bf16 v[136:139], a[184:187], a[104:107], v[136:139]
    v_mfma_f32_16x16x32_bf16 v[136:139], a[188:191], a[108:111], v[136:139]
    v_mfma_f32_16x16x32_bf16 v[140:143], a[176:179], a[112:115], 0
    v_mfma_f32_16x16x32_bf16 v[140:143], a[180:183], a[116:119], v[140:143]
    v_mfma_f32_16x16x32_bf16 v[140:143], a[184:187], a[120:123], v[140:143]
    v_mfma_f32_16x16x32_bf16 v[140:143], a[188:191], a[124:127], v[140:143]
    s_nop 7
    v_max3_f32 v252, v252, v80, v81
    v_max3_f32 v252, v252, v82, v83
    v_max3_f32 v253, v253, v84, v85
    v_max3_f32 v253, v253, v86, v87
    v_max3_f32 v254, v254, v88, v89
    v_max3_f32 v254, v254, v90, v91
    v_max3_f32 v255, v255, v92, v93
    v_max3_f32 v255, v255, v94, v95
    v_max3_f32 v252, v252, v96, v97
    v_max3_f32 v252, v252, v98, v99
    v_max3_f32 v253, v253, v100, v101
    v_max3_f32 v253, v253, v102, v103
    v_max3_f32 v254, v254, v104, v105
    v_max3_f32 v254, v254, v106, v107
    v_max3_f32 v255, v255, v108, v109
    v_max3_f32 v255, v255, v110, v111
    v_max3_f32 v252, v252, v112, v113
    v_max3_f32 v252, v252, v114, v115
    v_max3_f32 v253, v253, v116, v117
    v_max3_f32 v253, v253, v118, v119
    v_max3_f32 v254, v254, v120, v121
    v_max3_f32 v254, v254, v122, v123
    v_max3_f32 v255, v255, v124, v125
    v_max3_f32 v255, v255, v126, v127
    v_max3_f32 v252, v252, v128, v129
    v_max3_f32 v252, v252, v130, v131
    v_max3_f32 v253, v253, v132, v133
    v_max3_f32 v253, v253, v134, v135
    v_max3_f32 v254, v254, v136, v137
    v_max3_f32 v254, v254, v138, v139
    v_max3_f32 v255, v255, v140, v141
    v_max3_f32 v255, v255, v142, v143
    s_add_u32 s25, s25, 1
    s_cmp_lt_u32 s25, 16
    s_cbranch_scc1 L_fbloop
    ds_write_b128 v8, v[252:255]
    s_waitcnt lgkmcnt(0)
    s_barrier
    ds_read_b128 v[0:3], v9
    s_waitcnt lgkmcnt(0)
    v_max_f32 v252, v252, v2
    v_max_f32 v253, v253, v3
    v_max_f32 v254, v254, v0
    v_max_f32 v255, v255, v1
    v_mov_b32 v0, v252
    v_mov_b32 v1, v253
    v_mov_b32 v2, v254
    v_mov_b32 v3, v255
    v_permlane32_swap_b32 v252, v0
    v_permlane32_swap_b32 v253, v1
    v_permlane32_swap_b32 v254, v2
    v_permlane32_swap_b32 v255, v3
    v_max_f32 v252, v252, v0
    v_max_f32 v253, v253, v1
    v_max_f32 v254, v254, v2
    v_max_f32 v255, v255, v3
    v_mov_b32 v0, v252
    v_mov_b32 v1, v253
    v_mov_b32 v2, v254
    v_mov_b32 v3, v255
    v_permlane16_swap_b32 v252, v0
    v_permlane16_swap_b32 v253, v1
    v_permlane16_swap_b32 v254, v2
    v_permlane16_swap_b32 v255, v3
    v_max_f32 v252, v252, v0
    v_max_f32 v253, v253, v1
    v_max_f32 v254, v254, v2
    v_max_f32 v255, v255, v3
    s_mov_b32 s46, 0xc2300000
    v_add_f32 v252, s46, v252
    v_add_f32 v253, s46, v253
    v_add_f32 v254, s46, v254
    v_add_f32 v255, s46, v255
    s_barrier
    s_branch L_restart
L_nooff:
    s_mov_b32 s45, 12
    v_mov_b32 v16, 0
    v_mov_b32 v17, 0
    v_mov_b32 v18, 0
    v_mov_b32 v19, 0
    v_mov_b32 v20, 0
    v_mov_b32 v21, 0
    v_mov_b32 v22, 0
    v_mov_b32 v23, 0
    v_mov_b32 v24, 0
    v_mov_b32 v25, 0
    v_mov_b32 v26, 0
    v_mov_b32 v27, 0
    v_mov_b32 v28, 0
    v_mov_b32 v29, 0
    v_mov_b32 v30, 0
    v_mov_b32 v31, 0
    v_mov_b32 v32, 0
    v_mov_b32 v33, 0
    v_mov_b32 v34, 0
    v_mov_b32 v35, 0
    v_mov_b32 v36, 0
    v_mov_b32 v37, 0
    v_mov_b32 v38, 0
    v_mov_b32 v39, 0
    v_mov_b32 v40, 0
    v_mov_b32 v41, 0
    v_mov_b32 v42, 0
    v_mov_b32 v43, 0
    v_mov_b32 v44, 0
    v_mov_b32 v45, 0
    v_mov_b32 v46, 0
    v_mov_b32 v47, 0
    v_mov_b32 v48, 0
    v_mov_b32 v49, 0
    v_mov_b32 v50, 0
    v_mov_b32 v51, 0
    v_mov_b32 v52, 0
    v_mov_b32 v53, 0
    v_mov_b32 v54, 0
    v_mov_b32 v55, 0
    v_mov_b32 v56, 0
    v_mov_b32 v57, 0
    v_mov_b32 v58, 0
    v_mov_b32 v59, 0
    v_mov_b32 v60, 0
    v_mov_b32 v61, 0
    v_mov_b32 v62, 0
    v_mov_b32 v63, 0
    v_mov_b32 v64, 0
    v_mov_b32 v65, 0
    v_mov_b32 v66, 0
    v_mov_b32 v67, 0
    v_mov_b32 v68, 0
    v_mov_b32 v69, 0
    v_mov_b32 v70, 0
    v_mov_b32 v71, 0
    v_mov_b32 v72, 0
    v_mov_b32 v73, 0
    v_mov_b32 v74, 0
    v_mov_b32 v75, 0
    v_mov_b32 v76, 0
    v_mov_b32 v77, 0
    v_mov_b32 v78, 0
    v_mov_b32 v79, 0
    v_accvgpr_write_b32 a0, 0
    v_accvgpr_write_b32 a1, 0
    v_accvgpr_write_b32 a2, 0
    v_accvgpr_write_b32 a3, 0
    v_accvgpr_write_b32 a4, 0
    v_accvgpr_write_b32 a5, 0
    v_accvgpr_write_b32 a6, 0
    v_accvgpr_write_b32 a7, 0
    v_accvgpr_write_b32 a8, 0
    v_accvgpr_write_b32 a9, 0
    v_accvgpr_write_b32 a10, 0
    v_accvgpr_write_b32 a11, 0
    v_accvgpr_write_b32 a12, 0
    v_accvgpr_write_b32 a13, 0
    v_accvgpr_write_b32 a14, 0
    v_accvgpr_write_b32 a15, 0
    v_accvgpr_write_b32 a16, 0
    v_accvgpr_write_b32 a17, 0
    v_accvgpr_write_b32 a18, 0
    v_accvgpr_write_b32 a19, 0
    v_accvgpr_write_b32 a20, 0
    v_accvgpr_write_b32 a21, 0
    v_accvgpr_write_b32 a22, 0
    v_accvgpr_write_b32 a23, 0
    v_accvgpr_write_b32 a24, 0
    v_accvgpr_write_b32 a25, 0
    v_accvgpr_write_b32 a26, 0
    v_accvgpr_write_b32 a27, 0
    v_accvgpr_write_b32 a28, 0
    v_accvgpr_write_b32 a29, 0
    v_accvgpr_write_b32 a30, 0
    v_accvgpr_write_b32 a31, 0
    v_accvgpr_write_b32 a32, 0
    v_accvgpr_write_b32 a33, 0
    v_accvgpr_write_b32 a34, 0
    v_accvgpr_write_b32 a35, 0
    v_accvgpr_write_b32 a36, 0
    v_accvgpr_write_b32 a37, 0
    v_accvgpr_write_b32 a38, 0
    v_accvgpr_write_b32 a39, 0
    v_accvgpr_write_b32 a40, 0
    v_accvgpr_write_b32 a41, 0
    v_accvgpr_write_b32 a42, 0
    v_accvgpr_write_b32 a43, 0
    v_accvgpr_write_b32 a44, 0
    v_accvgpr_write_b32 a45, 0
    v_accvgpr_write_b32 a46, 0
    v_accvgpr_write_b32 a47, 0
    v_accvgpr_write_b32 a48, 0
    v_accvgpr_write_b32 a49, 0
    v_accvgpr_write_b32 a50, 0
    v_accvgpr_write_b32 a51, 0
    v_accvgpr_write_b32 a52, 0
    v_accvgpr_write_b32 a53, 0
    v_accvgpr_write_b32 a54, 0
    v_accvgpr_write_b32 a55, 0
    v_accvgpr_write_b32 a56, 0
    v_accvgpr_write_b32 a57, 0
    v_accvgpr_write_b32 a58, 0
    v_accvgpr_write_b32 a59, 0
    v_accvgpr_write_b32 a60, 0
    v_accvgpr_write_b32 a61, 0
    v_accvgpr_write_b32 a62, 0
    v_accvgpr_write_b32 a63, 0
    s_branch L_off
.fill 2048, 4, 0xbf800000
.section .rodata,"a"
.p2align 6
.amdhsa_kernel standalone__gqa_softmax__near_ridge_kernel
  .amdhsa_next_free_vgpr 512
  .amdhsa_next_free_sgpr 102
  .amdhsa_accum_offset 256
  .amdhsa_group_segment_fixed_size 0
  .amdhsa_kernarg_size 48
  .amdhsa_user_sgpr_count 2
  .amdhsa_user_sgpr_kernarg_segment_ptr 1
  .amdhsa_system_sgpr_workgroup_id_x 1
.end_amdhsa_kernel
```
